```python
import torch

def _softmax(x, axis=-1):
    return torch.softmax(x, dim=axis)
def _gelu(x):
    return torch.nn.functional.gelu(x, approximate="tanh")
def _silu(x):
    return torch.nn.functional.silu(x)
def _sigmoid(x):
    return torch.sigmoid(x)
def _layernorm(x, axis=-1, eps=1e-5):
    m = x.mean(dim=axis, keepdim=True)
    v = x.var(dim=axis, keepdim=True, unbiased=False)
    return (x - m) / torch.sqrt(v + eps)
def _scatter_add(tgt, idx, src, axis=0):
    return tgt.clone().index_add_(axis, idx, src)
def _segment_sum(src, seg, n):
    out = torch.zeros((n,) + src.shape[1:], dtype=src.dtype)
    return out.index_add_(0, seg, src)
def _pad(x, pw):
    flat = tuple(v for pair in reversed(pw) for v in pair)
    return torch.nn.functional.pad(x, flat)

kernel_name = 'gated_mix__linear_kernel_hedgehog__mha_block__prompt'

def setup_inputs():

    _w = (lambda a: (lambda t: t.to(torch.bfloat16) if t.is_floating_point() else t)(torch.as_tensor(a)))
    def _A_setup():
        B, S, D, H = 1, 2048, 1024, 32
        Dh = D // H
        return {
            "x": _w((lambda *s: torch.randn(*s, dtype=torch.bfloat16) * 0.05)(B, S, D)),
            "wqkv": _w((lambda *s: torch.randn(*s, dtype=torch.bfloat16) * 3.2)(D, 3 * D)),
            "w_phi": _w((lambda *s: torch.randn(*s, dtype=torch.bfloat16) * 3.2)(H, Dh, Dh) * (Dh ** -0.5)),
            "wo": _w((lambda *s: torch.randn(*s, dtype=torch.bfloat16) * 1.6)(D, D)),
        }
    _A_in = _A_setup()

    def _B_setup():
        B, S, D, H = 1, 2048, 1024, 32
        return {
            "x": _w((lambda *s: torch.randn(*s, dtype=torch.bfloat16) * 0.05)(B, S, D)),
            "wqkv": _w((lambda *s: torch.randn(*s, dtype=torch.bfloat16) * 3.2)(D, 3 * D)),
            "wo": _w((lambda *s: torch.randn(*s, dtype=torch.bfloat16) * 0.1)(D, D)),
        }
    _B_in = _B_setup()

    return {
        "A_x": _A_in["x"],
        "A_wqkv": _A_in["wqkv"],
        "A_w_phi": _A_in["w_phi"],
        "A_wo": _A_in["wo"],
        "B_x": _B_in["x"],
        "B_wqkv": _B_in["wqkv"],
        "B_wo": _B_in["wo"],
        "gate_w": _w((lambda *s: torch.randn(*s, dtype=torch.bfloat16) * 0.4)(1024) * 16.0),
    }

def reference(A_x, A_wqkv, A_w_phi, A_wo, B_x, B_wqkv, B_wo, gate_w):
    def _A_ref(x, wqkv, w_phi, wo):
        B, S, D = x.shape
        H = 32; Dh = D // H
        qkv = (lambda x, *d: x.permute(*d))((x @ wqkv).reshape(B, S, 3, H, Dh), 2, 0, 3, 1, 4)
        q, k, v = qkv[0], qkv[1], qkv[2]
        pq = torch.einsum("bhsd,hdf->bhsf", q, w_phi)
        pk = torch.einsum("bhsd,hdf->bhsf", k, w_phi)
        phi_q = torch.concatenate([_softmax(pq, axis=-1), _softmax(-pq, axis=-1)], axis=-1)
        phi_k = torch.concatenate([_softmax(pk, axis=-1), _softmax(-pk, axis=-1)], axis=-1)
        kv = torch.einsum("bhsf,bhsd->bhfd", phi_k, v)
        z  = torch.einsum("bhsf->bhf", phi_k)
        num = torch.einsum("bhqf,bhfd->bhqd", phi_q, kv)
        den = torch.einsum("bhqf,bhf->bhq", phi_q, z)[..., None] + 1e-6
        o = num / den
        return (lambda x, *d: x.permute(*d))(o, 0, 2, 1, 3).reshape(B, S, D) @ wo

    def _B_ref(x, wqkv, wo):
        B, S, D = x.shape
        H = 32
        Dh = D // H
        qkv = (lambda x, *d: x.permute(*d))((x @ wqkv).reshape(B, S, 3, H, Dh), 2, 0, 3, 1, 4)
        q, k, v = qkv[0], qkv[1], qkv[2]
        scores = torch.einsum("bhqd,bhkd->bhqk", q, k) * (Dh ** -0.5)
        p = _softmax(scores, axis=-1)
        o = torch.einsum("bhqk,bhkd->bhqd", p, v)
        return (lambda x, *d: x.permute(*d))(o, 0, 2, 1, 3).reshape(B, S, D) @ wo

    x = A_x
    g = _sigmoid((x * gate_w).sum(-1, keepdims=True))
    a = _A_ref(x, A_wqkv, A_w_phi, A_wo)
    b = _B_ref(x, B_wqkv, B_wo)
    return g * a + (1 - g) * b
```

```asm
; @launch kernel=qkv_kernel grid=(256,1,1) block=(512,1,1) lds=151552
.amdgcn_target "amdgcn-amd-amdhsa--gfx950"
.text
.p2align 12
.fill 64, 4, 0xbf800000
.globl qkv_kernel
.p2align 8
.type qkv_kernel,@function
qkv_kernel:
    s_cmp_ge_u32 s2, 256
    s_cbranch_scc1 K1_END
    s_load_dwordx4 s[4:7], s[0:1], 0
    s_load_dwordx2 s[46:47], s[0:1], 16
    s_load_dwordx2 s[48:49], s[0:1], 40
    s_load_dwordx2 s[50:51], s[0:1], 56
    s_load_dwordx2 s[52:53], s[0:1], 80
    s_load_dwordx2 s[94:95], s[0:1], 72
    v_lshrrev_b32 v2, 6, v0
    v_and_b32 v1, 63, v0
    v_readfirstlane_b32 s32, v2
    s_and_b32 s44, s2, 7
    s_bfe_u32 s43, s2, 0x10003
    s_lshl_b32 s55, s44, 1
    s_add_u32 s55, s55, s43
    s_bfe_u32 s33, s2, 0x10004
    s_lshr_b32 s35, s2, 5
    s_lshr_b32 s3, s32, 2
    s_and_b32 s34, s32, 3
    s_lshl_b32 s41, s55, 1
    s_add_u32 s41, s41, s3
    v_lshrrev_b32 v3, 3, v1
    v_and_b32 v4, 7, v1
    v_lshrrev_b32 v5, 4, v1
    s_lshl_b32 s43, s35, 8
    s_lshl_b32 s44, s32, 5
    s_add_u32 s43, s43, s44
    v_add_u32 v6, s43, v3
    v_lshlrev_b32 v6, 11, v6
    v_xor_b32 v7, v4, v5
    v_lshlrev_b32 v7, 4, v7
    v_add_u32 v196, v6, v7
    v_add_u32 v198, 0x8000, v196
    v_xor_b32 v7, 64, v7
    v_add_u32 v197, v6, v7
    v_add_u32 v197, 0x4000, v197
    v_add_u32 v199, 0x8000, v197
    s_lshl_b32 s44, s32, 3
    v_add_u32 v6, s44, v3
    v_mul_u32_u24 v6, 6144, v6
    v_and_b32 v7, 1, v5
    v_lshlrev_b32 v7, 2, v7
    v_xor_b32 v7, v4, v7
    s_and_b32 s44, s32, 1
    s_lshl_b32 s44, s44, 1
    v_xor_b32 v7, s44, v7
    v_lshl_add_u32 v200, v7, 4, v6
    v_lshlrev_b32 v15, 4, v1
    s_lshl_b32 s39, s32, 12
    s_lshl_b32 s40, s32, 10
    s_add_u32 s40, s40, 98304
    s_mov_b32 s36, 0
    s_mov_b32 s37, 0
    s_mov_b32 s83, 0x600000
    s_cmp_ge_u32 s32, 4
    s_cbranch_scc1 K1_H
K1_D:
    s_lshl_b32 s43, s55, 7
    s_lshl_b32 s44, s33, 11
    s_add_u32 s45, s43, 2048
    s_sub_u32 s45, s45, s44
    s_add_u32 s44, s43, 4096
    s_lshr_b32 s62, s2, 3
    s_cmp_ge_u32 s32, 2
    s_cbranch_scc1 K1_TW
    s_lshl_b32 s62, s62, 1
    s_add_u32 s62, s62, s32
    s_lshl_b32 s62, s62, 16
    v_and_b32 v8, 31, v1
    v_lshlrev_b32 v8, 11, v8
    v_add_u32 v201, s62, v8
    s_branch K1_TD
K1_TW:
    s_mul_i32 s62, s62, 12
    v_and_b32 v8, 15, v1
    v_min_u32 v8, 11, v8
    v_add_u32 v8, s62, v8
    v_and_b32 v9, 63, v8
    v_mul_u32_u24 v9, 6144, v9
    v_lshrrev_b32 v8, 6, v8
    v_and_b32 v10, 1, v8
    v_lshrrev_b32 v8, 1, v8
    v_lshl_add_u32 v9, v8, 11, v9
    v_lshl_add_u32 v9, v10, 7, v9
    s_and_b32 s62, s2, 7
    s_lshl_b32 s62, s62, 8
    v_add_u32 v201, s62, v9
K1_TD:
    s_waitcnt lgkmcnt(0)
    s_cmp_ge_u32 s32, 4
    s_cbranch_scc1 K1_TX
    s_cmp_eq_u32 s32, 2
    s_cselect_b32 s96, s6, s48
    s_cselect_b32 s97, s7, s49
    s_cmp_lt_u32 s32, 2
    s_cselect_b32 s96, s4, s96
    s_cselect_b32 s97, s5, s97
    s_cselect_b32 s98, 0x400000, s83
    s_mov_b32 s99, 0x20000
    buffer_load_dword v202, v201, s[96:99], 0 offen
K1_TX:
    s_mov_b32 s8, s4
    s_mov_b32 s9, s5
    s_mov_b32 s10, 0x400000
    s_mov_b32 s11, 0x20000
    s_add_u32 s12, s6, s45
    s_addc_u32 s13, s7, 0
    s_sub_u32 s14, 0x600000, s45
    s_mov_b32 s15, 0x20000
    s_add_u32 s16, s48, s45
    s_addc_u32 s17, s49, 0
    s_sub_u32 s18, 0x600000, s45
    s_mov_b32 s19, 0x20000
    s_cmp_eq_u32 s33, 0
    s_cselect_b32 s62, s6, s48
    s_cselect_b32 s63, s7, s49
    s_add_u32 s20, s62, s44
    s_addc_u32 s21, s63, 0
    s_sub_u32 s22, 0x600000, s44
    s_mov_b32 s23, 0x20000
    s_and_b32 s62, s2, 3
    s_lshr_b32 s63, s2, 2
    s_mul_i32 s90, s63, 3
    s_add_u32 s90, s90, s62
    s_sub_u32 s90, s90, 1
    s_cmp_ge_u32 s90, 96
    s_cselect_b32 s56, s48, s6
    s_cselect_b32 s57, s49, s7
    s_cselect_b32 s91, 96, 0
    s_sub_u32 s90, s90, s91
    s_mov_b32 s91, 393216
    s_cmp_eq_u32 s62, 0
    s_cselect_b32 s56, s4, s56
    s_cselect_b32 s57, s5, s57
    s_cselect_b32 s58, s10, 0x600000
    s_mov_b32 s59, 0x20000
    s_cselect_b32 s90, s63, s90
    s_cselect_b32 s91, 128, s91
    s_cselect_b32 s62, 13, 9
    s_cselect_b32 s63, 11, 7
    s_lshl_b32 s90, s90, 3
    s_add_u32 s90, s90, s32
    s_lshl_b32 s90, s90, s62
    v_lshlrev_b32 v8, s63, v5
    v_and_b32 v9, 15, v1
    v_lshl_add_u32 v8, v9, 3, v8
    v_add_u32 v204, s90, v8
    s_mul_i32 s92, s91, 15
    s_mul_i32 s90, s91, 2
    s_add_u32 m0, s39, 0
    s_nop 0
    buffer_load_dwordx4 v196, s[8:11], s36 offen lds
    s_add_u32 m0, s39, 1024
    s_nop 0
    buffer_load_dwordx4 v197, s[8:11], s36 offen lds
    s_add_u32 m0, s39, 2048
    s_nop 0
    buffer_load_dwordx4 v198, s[8:11], s36 offen lds
    s_add_u32 m0, s39, 3072
    s_nop 0
    buffer_load_dwordx4 v199, s[8:11], s36 offen lds
    s_add_u32 m0, s40, 0
    s_nop 0
    buffer_load_dwordx4 v200, s[12:15], s37 offen lds
    s_add_u32 m0, s40, 8192
    s_nop 0
    buffer_load_dwordx4 v200, s[16:19], s37 offen lds
    s_add_u32 m0, s40, 16384
    s_nop 0
    buffer_load_dwordx4 v200, s[20:23], s37 offen lds
    s_add_u32 s36, s36, 128
    s_add_u32 s37, s37, 393216
    s_mov_b32 s28, s46
    s_mov_b32 s29, s47
    s_mov_b32 s30, 0x10000
    s_mov_b32 s31, 0x20000
    s_lshl_b32 s43, s34, 10
    s_add_u32 m0, s43, 147456
    s_lshl_b32 s44, s55, 12
    s_add_u32 s43, s43, s44
    buffer_load_dwordx4 v15, s[28:31], s43 offen lds
    s_mov_b32 s28, s50
    s_mov_b32 s29, s51
    s_mov_b32 s30, 0x800
    s_mov_b32 s31, 0x20000
    s_lshl_b32 s42, s35, 3
    s_lshl_b32 s44, s34, 1
    s_add_u32 s42, s42, s44
    s_lshl_b32 s43, s41, 6
    s_add_u32 s42, s42, s43
    s_lshl_b32 s54, s35, 4
    s_add_u32 s54, s54, s55
    s_lshl_b32 s54, s54, 1
    s_add_u32 s54, s54, s33
    s_lshl_b32 s54, s54, 3
    s_add_u32 s54, s54, s32
    s_mov_b32 s60, 0x3fb8aa3b
    s_mov_b32 s61, 0x3fb8aa3b
    s_cmp_ge_u32 s32, 4
    s_cbranch_scc1 K1_I
K1_H:
    v_lshrrev_b32 v3, 5, v1
    v_and_b32 v4, 31, v1
    v_lshrrev_b32 v10, 4, v1
    v_and_b32 v11, 15, v1
    s_lshl_b32 s45, s34, 13
    v_lshlrev_b32 v6, 7, v11
    v_add_u32 v6, s45, v6
    v_lshrrev_b32 v7, 1, v11
    v_xor_b32 v7, v10, v7
    v_xor_b32 v8, 0, v7
    v_lshl_add_u32 v192, v8, 4, v6
    v_xor_b32 v8, 4, v7
    v_lshl_add_u32 v193, v8, 4, v6
    v_bfe_u32 v6, v1, 2, 2
    v_and_b32 v9, 3, v1
    v_lshlrev_b32 v9, 3, v9
    v_lshl_add_u32 v7, v10, 3, v6
    v_lshl_add_u32 v7, v7, 7, v9
    v_and_b32 v8, 2, v6
    v_and_b32 v12, 1, v10
    v_or_b32 v8, v8, v12
    s_lshl_b32 s43, s3, 1
    v_xor_b32 v8, s43, v8
    v_lshl_add_u32 v7, v8, 5, v7
    v_add_u32 v194, 98304, v7
    v_xor_b32 v195, 32, v194
    v_bfe_u32 v8, v1, 4, 1
    v_lshl_add_u32 v9, v8, 5, v9
    v_lshl_add_u32 v7, v3, 3, v6
    v_lshl_add_u32 v7, v7, 6, v9
    s_lshl_b32 s43, s3, 11
    s_add_u32 s43, s43, 147456
    v_add_u32 v203, s43, v7
    v_lshrrev_b32 v6, 4, v4
    v_bfe_u32 v7, v4, 3, 1
    v_lshlrev_b32 v6, 2, v6
    v_lshl_add_u32 v6, v7, 1, v6
    v_bfe_u32 v7, v4, 1, 1
    v_add_u32 v6, v6, v7
    v_and_b32 v7, 1, v4
    v_lshlrev_b32 v7, 4, v7
    v_mov_b32 v8, 0x3f80
    v_lshlrev_b32 v8, v7, v8
    v_bfe_u32 v7, v4, 2, 1
    v_cmp_eq_u32 vcc, v7, v3
    s_nop 1
    v_cndmask_b32 v8, 0, v8, vcc
    v_cmp_eq_u32 vcc, 0, v6
    s_nop 1
    v_cndmask_b32 v224, 0, v8, vcc
    v_cmp_eq_u32 vcc, 1, v6
    s_nop 1
    v_cndmask_b32 v225, 0, v8, vcc
    v_cmp_eq_u32 vcc, 2, v6
    s_nop 1
    v_cndmask_b32 v226, 0, v8, vcc
    v_cmp_eq_u32 vcc, 3, v6
    s_nop 1
    v_cndmask_b32 v227, 0, v8, vcc
    v_cmp_eq_u32 vcc, 4, v6
    s_nop 1
    v_cndmask_b32 v228, 0, v8, vcc
    v_cmp_eq_u32 vcc, 5, v6
    s_nop 1
    v_cndmask_b32 v229, 0, v8, vcc
    v_cmp_eq_u32 vcc, 6, v6
    s_nop 1
    v_cndmask_b32 v230, 0, v8, vcc
    v_cmp_eq_u32 vcc, 7, v6
    s_nop 1
    v_cndmask_b32 v231, 0, v8, vcc
    v_and_b32 v6, 3, v1
    v_bfe_u32 v7, v1, 2, 1
    v_bfe_u32 v8, v1, 4, 1
    v_xor_b32 v7, v7, v8
    v_or_b32 v6, v6, v7
    v_mov_b32 v8, 0x3f803f80
    v_cmp_eq_u32 vcc, 0, v6
    s_nop 1
    v_cndmask_b32 v232, 0, v8, vcc
    v_cndmask_b32 v233, 0, v8, vcc
    v_cndmask_b32 v234, 0, v8, vcc
    v_cndmask_b32 v235, 0, v8, vcc
    s_cmp_ge_u32 s32, 4
    s_cbranch_scc1 K1_D
K1_I:
    s_mov_b32 s24, s52
    s_mov_b32 s25, s53
    s_mov_b32 s26, 0x2000000
    s_mov_b32 s27, 0x20000
    s_lshl_b32 s93, s2, 3
    s_add_u32 s93, s93, s32
    s_lshl_b32 s93, s93, 10
    s_cmp_lt_u32 s2, 16
    s_cselect_b32 s93, s93, 0
    s_cselect_b32 s101, 0, 0x40000000
    s_add_u32 s93, s93, 24117248
    v_add_u32 v20, s101, v15
    v_mov_b32 v16, 0
    v_mov_b32 v17, 0
    v_mov_b32 v18, 0
    v_mov_b32 v19, 0
    s_barrier
    buffer_store_dwordx4 v[16:19], v20, s[24:27], s93 offen sc1
    s_add_u32 m0, s39, 32768
    s_nop 0
    buffer_load_dwordx4 v196, s[8:11], s36 offen lds
    s_add_u32 m0, s39, 33792
    s_nop 0
    buffer_load_dwordx4 v197, s[8:11], s36 offen lds
    s_add_u32 m0, s39, 34816
    s_nop 0
    buffer_load_dwordx4 v198, s[8:11], s36 offen lds
    s_add_u32 m0, s39, 35840
    s_nop 0
    buffer_load_dwordx4 v199, s[8:11], s36 offen lds
    s_add_u32 m0, s40, 24576
    s_nop 0
    buffer_load_dwordx4 v200, s[12:15], s37 offen lds
    s_add_u32 m0, s40, 32768
    s_nop 0
    buffer_load_dwordx4 v200, s[16:19], s37 offen lds
    s_add_u32 m0, s40, 40960
    s_nop 0
    buffer_load_dwordx4 v200, s[20:23], s37 offen lds
    s_add_u32 s36, s36, 128
    s_add_u32 s37, s37, 393216
    s_mov_b32 s24, s52
    s_mov_b32 s25, s53
    s_mov_b32 s26, 0x2000000
    s_mov_b32 s27, 0x20000
    buffer_load_dword v202, v204, s[56:59], s90 offen
    s_add_u32 s90, s90, s91
    s_min_u32 s90, s90, s92
    buffer_load_dword v202, v204, s[56:59], s90 offen
    s_add_u32 s90, s90, s91
    s_min_u32 s90, s90, s92
    s_mov_b32 s88, 32768
    s_mov_b32 s89, 0xffff0000
    s_mov_b32 s87, 32768
    s_mov_b32 s86, 32768
    s_mov_b32 s84, s39
    s_cmp_lt_u32 s2, 16
    s_cselect_b32 s43, 0, 1
    s_or_b32 s43, s43, s32
    v_or_b32 v252, s43, v1
    s_lshl_b32 s43, s2, 2
    v_mov_b32 v2, s43
    v_mov_b32 v3, 0x40000000
    v_cmp_eq_u32 vcc, 0, v252
    s_nop 1
    v_cndmask_b32 v252, v3, v2, vcc
    v_min_u32 v253, 15, v1
    v_lshlrev_b32 v253, 2, v253
    v_mov_b32 v255, 1
    v_mov_b32 v14, 0
    s_lshl_b32 s43, s55, 4
    v_add_u32 v2, s43, v1
    v_lshlrev_b32 v2, 9, v2
    s_lshl_b32 s43, s33, 3
    s_add_u32 s43, s43, s35
    s_lshl_b32 s43, s43, 2
    v_add_u32 v254, s43, v2
    s_lshl_b32 s43, s55, 1
    s_add_u32 s43, s43, s33
    s_add_u32 s43, s43, 16
    s_lshl_b32 s43, s43, 2
    v_subrev_u32 v3, 16, v1
    v_lshlrev_b32 v3, 3, v3
    v_add_u32 v3, s35, v3
    v_lshlrev_b32 v3, 9, v3
    v_add_u32 v3, s43, v3
    v_cmp_gt_u32 vcc, 16, v1
    s_nop 1
    v_cndmask_b32 v254, v3, v254, vcc
    s_and_b32 s43, s2, 7
    s_lshl_b32 s43, s43, 2
    s_bfe_u32 s44, s2, 0x20003
    s_add_u32 s43, s43, s44
    s_lshl_b32 s43, s43, 3
    s_add_u32 s43, s43, s35
    s_lshl_b32 s43, s43, 9
    s_add_u32 s100, s43, 24117504
    s_waitcnt vmcnt(10)
    s_barrier
    ds_read_b64_tr_b16 v[144:145], v194 offset:0
    ds_read_b64_tr_b16 v[146:147], v194 offset:512
    ds_read_b64_tr_b16 v[148:149], v195 offset:0
    ds_read_b64_tr_b16 v[150:151], v195 offset:512
    ds_read_b64_tr_b16 v[152:153], v194 offset:8192
    ds_read_b64_tr_b16 v[154:155], v194 offset:8704
    ds_read_b64_tr_b16 v[156:157], v195 offset:8192
    ds_read_b64_tr_b16 v[158:159], v195 offset:8704
    ds_read_b128 v[112:115], v192 offset:0
    ds_read_b128 v[116:119], v192 offset:2048
    ds_read_b128 v[120:123], v192 offset:4096
    ds_read_b128 v[124:127], v192 offset:6144
    ds_read_b64_tr_b16 v[160:161], v194 offset:16384
    ds_read_b64_tr_b16 v[162:163], v194 offset:16896
    ds_read_b64_tr_b16 v[164:165], v195 offset:16384
    ds_read_b64_tr_b16 v[166:167], v195 offset:16896
    v_add_u32 v192, s87, v192
    s_waitcnt lgkmcnt(0)
    v_mfma_f32_16x16x32_bf16 v[16:19], v[144:147], v[112:115], 0
    s_add_u32 m0, s39, 65536
    ds_read_b64_tr_b16 v[168:169], v194 offset:4096
    buffer_load_dwordx4 v196, s[8:11], s36 offen lds
    v_mfma_f32_16x16x32_bf16 v[24:27], v[148:151], v[112:115], 0
    ds_read_b64_tr_b16 v[170:171], v194 offset:4608
    v_mfma_f32_16x16x32_bf16 v[48:51], v[152:155], v[112:115], 0
    ds_read_b64_tr_b16 v[172:173], v195 offset:4096
    v_mfma_f32_16x16x32_bf16 v[56:59], v[156:159], v[112:115], 0
    ds_read_b64_tr_b16 v[174:175], v195 offset:4608
    v_mfma_f32_16x16x32_bf16 v[80:83], v[112:115], v[160:163], 0
    s_add_u32 m0, s39, 66560
    ds_read_b64_tr_b16 v[176:177], v194 offset:12288
    buffer_load_dwordx4 v197, s[8:11], s36 offen lds
    v_mfma_f32_16x16x32_bf16 v[84:87], v[112:115], v[164:167], 0
    ds_read_b64_tr_b16 v[178:179], v194 offset:12800
    v_mfma_f32_16x16x32_bf16 v[20:23], v[144:147], v[116:119], 0
    ds_read_b64_tr_b16 v[180:181], v195 offset:12288
    v_mfma_f32_16x16x32_bf16 v[28:31], v[148:151], v[116:119], 0
    ds_read_b64_tr_b16 v[182:183], v195 offset:12800
    v_mfma_f32_16x16x32_bf16 v[52:55], v[152:155], v[116:119], 0
    s_add_u32 m0, s39, 67584
    ds_read_b128 v[128:131], v193 offset:0
    buffer_load_dwordx4 v198, s[8:11], s36 offen lds
    v_mfma_f32_16x16x32_bf16 v[60:63], v[156:159], v[116:119], 0
    ds_read_b128 v[132:135], v193 offset:2048
    v_mfma_f32_16x16x32_bf16 v[88:91], v[116:119], v[160:163], 0
    ds_read_b128 v[136:139], v193 offset:4096
    v_mfma_f32_16x16x32_bf16 v[92:95], v[116:119], v[164:167], 0
    ds_read_b128 v[140:143], v193 offset:6144
    v_mfma_f32_16x16x32_bf16 v[32:35], v[144:147], v[120:123], 0
    s_add_u32 m0, s39, 68608
    ds_read_b64_tr_b16 v[184:185], v194 offset:20480
    buffer_load_dwordx4 v199, s[8:11], s36 offen lds
    s_add_u32 s36, s36, 128
    v_mfma_f32_16x16x32_bf16 v[40:43], v[148:151], v[120:123], 0
    ds_read_b64_tr_b16 v[186:187], v194 offset:20992
    v_mfma_f32_16x16x32_bf16 v[64:67], v[152:155], v[120:123], 0
    ds_read_b64_tr_b16 v[188:189], v195 offset:20480
    v_mfma_f32_16x16x32_bf16 v[72:75], v[156:159], v[120:123], 0
    ds_read_b64_tr_b16 v[190:191], v195 offset:20992
    v_mfma_f32_16x16x32_bf16 v[96:99], v[120:123], v[160:163], 0
    v_mfma_f32_16x16x32_bf16 v[100:103], v[120:123], v[164:167], 0
    v_mfma_f32_16x16x32_bf16 v[36:39], v[144:147], v[124:127], 0
    buffer_load_dword v202, v204, s[56:59], s90 offen
    v_mfma_f32_16x16x32_bf16 v[44:47], v[148:151], v[124:127], 0
    v_mfma_f32_16x16x32_bf16 v[68:71], v[152:155], v[124:127], 0
    v_mfma_f32_16x16x32_bf16 v[76:79], v[156:159], v[124:127], 0
    s_add_u32 s90, s90, s91
    v_mfma_f32_16x16x32_bf16 v[104:107], v[124:127], v[160:163], 0
    v_add_u32 v193, s87, v193
    v_mfma_f32_16x16x32_bf16 v[108:111], v[124:127], v[164:167], 0
    s_min_u32 s90, s90, s92
    s_waitcnt vmcnt(7) lgkmcnt(0)
    s_barrier
    v_mfma_f32_16x16x32_bf16 v[16:19], v[168:171], v[128:131], v[16:19]
    s_add_u32 m0, s40, 0
    ds_read_b64_tr_b16 v[144:145], v194 offset:24576
    buffer_load_dwordx4 v200, s[12:15], s37 offen lds
    v_mfma_f32_16x16x32_bf16 v[24:27], v[172:175], v[128:131], v[24:27]
    ds_read_b64_tr_b16 v[146:147], v194 offset:25088
    v_mfma_f32_16x16x32_bf16 v[48:51], v[176:179], v[128:131], v[48:51]
    ds_read_b64_tr_b16 v[148:149], v195 offset:24576
    v_mfma_f32_16x16x32_bf16 v[56:59], v[180:183], v[128:131], v[56:59]
    s_add_u32 m0, s40, 8192
    ds_read_b64_tr_b16 v[150:151], v195 offset:25088
    buffer_load_dwordx4 v200, s[16:19], s37 offen lds
    v_mfma_f32_16x16x32_bf16 v[80:83], v[128:131], v[184:187], v[80:83]
    ds_read_b64_tr_b16 v[152:153], v194 offset:32768
    v_mfma_f32_16x16x32_bf16 v[84:87], v[128:131], v[188:191], v[84:87]
    ds_read_b64_tr_b16 v[154:155], v194 offset:33280
    v_mfma_f32_16x16x32_bf16 v[20:23], v[168:171], v[132:135], v[20:23]
    s_add_u32 m0, s40, 16384
    ds_read_b64_tr_b16 v[156:157], v195 offset:32768
    buffer_load_dwordx4 v200, s[20:23], s37 offen lds
    s_add_u32 s37, s37, 393216
    v_mfma_f32_16x16x32_bf16 v[28:31], v[172:175], v[132:135], v[28:31]
    ds_read_b64_tr_b16 v[158:159], v195 offset:33280
    v_mfma_f32_16x16x32_bf16 v[52:55], v[176:179], v[132:135], v[52:55]
    ds_read_b128 v[112:115], v192 offset:0
    v_mfma_f32_16x16x32_bf16 v[60:63], v[180:183], v[132:135], v[60:63]
    ds_read_b128 v[116:119], v192 offset:2048
    v_mfma_f32_16x16x32_bf16 v[88:91], v[132:135], v[184:187], v[88:91]
    ds_read_b128 v[120:123], v192 offset:4096
    v_mfma_f32_16x16x32_bf16 v[92:95], v[132:135], v[188:191], v[92:95]
    ds_read_b128 v[124:127], v192 offset:6144
    v_mfma_f32_16x16x32_bf16 v[32:35], v[168:171], v[136:139], v[32:35]
    ds_read_b64_tr_b16 v[160:161], v194 offset:40960
    v_mfma_f32_16x16x32_bf16 v[40:43], v[172:175], v[136:139], v[40:43]
    ds_read_b64_tr_b16 v[162:163], v194 offset:41472
    v_mfma_f32_16x16x32_bf16 v[64:67], v[176:179], v[136:139], v[64:67]
    ds_read_b64_tr_b16 v[164:165], v195 offset:40960
    v_mfma_f32_16x16x32_bf16 v[72:75], v[180:183], v[136:139], v[72:75]
    ds_read_b64_tr_b16 v[166:167], v195 offset:41472
    v_mfma_f32_16x16x32_bf16 v[96:99], v[136:139], v[184:187], v[96:99]
    v_mfma_f32_16x16x32_bf16 v[100:103], v[136:139], v[188:191], v[100:103]
    v_mfma_f32_16x16x32_bf16 v[36:39], v[168:171], v[140:143], v[36:39]
    s_add_u32 s85, s84, s87
    v_mfma_f32_16x16x32_bf16 v[44:47], v[172:175], v[140:143], v[44:47]
    s_cmp_eq_u32 s86, 65536
    v_mfma_f32_16x16x32_bf16 v[68:71], v[176:179], v[140:143], v[68:71]
    s_cselect_b32 s87, s89, s88
    v_mfma_f32_16x16x32_bf16 v[76:79], v[180:183], v[140:143], v[76:79]
    s_add_u32 s86, s86, s87
    v_mfma_f32_16x16x32_bf16 v[104:107], v[140:143], v[184:187], v[104:107]
    v_add_u32 v192, s87, v192
    v_mfma_f32_16x16x32_bf16 v[108:111], v[140:143], v[188:191], v[108:111]
    s_mov_b32 s96, s94
    s_mov_b32 s97, s95
    s_mov_b32 s98, 0x100
    s_mov_b32 s99, 0x20000
    buffer_store_dword v255, v252, s[96:99], 0 offen sc1
    s_mov_b32 s93, 24117504
    s_mov_b32 s38, 6
K1_LOOP:
    s_waitcnt lgkmcnt(0)
    v_mfma_f32_16x16x32_bf16 v[16:19], v[144:147], v[112:115], v[16:19]
    s_add_u32 m0, s84, 0
    ds_read_b64_tr_b16 v[168:169], v194 offset:28672
    buffer_load_dwordx4 v196, s[8:11], s36 offen lds
    v_mfma_f32_16x16x32_bf16 v[24:27], v[148:151], v[112:115], v[24:27]
    ds_read_b64_tr_b16 v[170:171], v194 offset:29184
    v_mfma_f32_16x16x32_bf16 v[48:51], v[152:155], v[112:115], v[48:51]
    ds_read_b64_tr_b16 v[172:173], v195 offset:28672
    v_mfma_f32_16x16x32_bf16 v[56:59], v[156:159], v[112:115], v[56:59]
    ds_read_b64_tr_b16 v[174:175], v195 offset:29184
    v_mfma_f32_16x16x32_bf16 v[80:83], v[112:115], v[160:163], v[80:83]
    s_add_u32 m0, s84, 1024
    ds_read_b64_tr_b16 v[176:177], v194 offset:36864
    buffer_load_dwordx4 v197, s[8:11], s36 offen lds
    v_mfma_f32_16x16x32_bf16 v[84:87], v[112:115], v[164:167], v[84:87]
    ds_read_b64_tr_b16 v[178:179], v194 offset:37376
    v_mfma_f32_16x16x32_bf16 v[20:23], v[144:147], v[116:119], v[20:23]
    ds_read_b64_tr_b16 v[180:181], v195 offset:36864
    v_mfma_f32_16x16x32_bf16 v[28:31], v[148:151], v[116:119], v[28:31]
    ds_read_b64_tr_b16 v[182:183], v195 offset:37376
    v_mfma_f32_16x16x32_bf16 v[52:55], v[152:155], v[116:119], v[52:55]
    s_add_u32 m0, s84, 2048
    ds_read_b128 v[128:131], v193 offset:0
    buffer_load_dwordx4 v198, s[8:11], s36 offen lds
    v_mfma_f32_16x16x32_bf16 v[60:63], v[156:159], v[116:119], v[60:63]
    ds_read_b128 v[132:135], v193 offset:2048
    v_mfma_f32_16x16x32_bf16 v[88:91], v[116:119], v[160:163], v[88:91]
    ds_read_b128 v[136:139], v193 offset:4096
    v_mfma_f32_16x16x32_bf16 v[92:95], v[116:119], v[164:167], v[92:95]
    ds_read_b128 v[140:143], v193 offset:6144
    v_mfma_f32_16x16x32_bf16 v[32:35], v[144:147], v[120:123], v[32:35]
    s_add_u32 m0, s84, 3072
    ds_read_b64_tr_b16 v[184:185], v194 offset:45056
    buffer_load_dwordx4 v199, s[8:11], s36 offen lds
    s_add_u32 s36, s36, 128
    s_mov_b32 s84, s85
    v_mfma_f32_16x16x32_bf16 v[40:43], v[148:151], v[120:123], v[40:43]
    ds_read_b64_tr_b16 v[186:187], v194 offset:45568
    v_mfma_f32_16x16x32_bf16 v[64:67], v[152:155], v[120:123], v[64:67]
    ds_read_b64_tr_b16 v[188:189], v195 offset:45056
    v_mfma_f32_16x16x32_bf16 v[72:75], v[156:159], v[120:123], v[72:75]
    ds_read_b64_tr_b16 v[190:191], v195 offset:45568
    v_mfma_f32_16x16x32_bf16 v[96:99], v[120:123], v[160:163], v[96:99]
    v_mfma_f32_16x16x32_bf16 v[100:103], v[120:123], v[164:167], v[100:103]
    v_mfma_f32_16x16x32_bf16 v[36:39], v[144:147], v[124:127], v[36:39]
    buffer_load_dword v202, v204, s[56:59], s90 offen
    v_mfma_f32_16x16x32_bf16 v[44:47], v[148:151], v[124:127], v[44:47]
    v_mfma_f32_16x16x32_bf16 v[68:71], v[152:155], v[124:127], v[68:71]
    v_mfma_f32_16x16x32_bf16 v[76:79], v[156:159], v[124:127], v[76:79]
    s_add_u32 s90, s90, s91
    v_mfma_f32_16x16x32_bf16 v[104:107], v[124:127], v[160:163], v[104:107]
    v_add_u32 v193, s87, v193
    v_mfma_f32_16x16x32_bf16 v[108:111], v[124:127], v[164:167], v[108:111]
    s_min_u32 s90, s90, s92
    s_waitcnt vmcnt(5) lgkmcnt(0)
    s_barrier
    v_mfma_f32_16x16x32_bf16 v[16:19], v[168:171], v[128:131], v[16:19]
    s_add_u32 m0, s40, 24576
    ds_read_b64_tr_b16 v[144:145], v194 offset:0
    buffer_load_dwordx4 v200, s[12:15], s37 offen lds
    v_mfma_f32_16x16x32_bf16 v[24:27], v[172:175], v[128:131], v[24:27]
    ds_read_b64_tr_b16 v[146:147], v194 offset:512
    v_mfma_f32_16x16x32_bf16 v[48:51], v[176:179], v[128:131], v[48:51]
    ds_read_b64_tr_b16 v[148:149], v195 offset:0
    v_mfma_f32_16x16x32_bf16 v[56:59], v[180:183], v[128:131], v[56:59]
    s_add_u32 m0, s40, 32768
    ds_read_b64_tr_b16 v[150:151], v195 offset:512
    buffer_load_dwordx4 v200, s[16:19], s37 offen lds
    v_mfma_f32_16x16x32_bf16 v[80:83], v[128:131], v[184:187], v[80:83]
    ds_read_b64_tr_b16 v[152:153], v194 offset:8192
    v_mfma_f32_16x16x32_bf16 v[84:87], v[128:131], v[188:191], v[84:87]
    ds_read_b64_tr_b16 v[154:155], v194 offset:8704
    v_mfma_f32_16x16x32_bf16 v[20:23], v[168:171], v[132:135], v[20:23]
    s_add_u32 m0, s40, 40960
    ds_read_b64_tr_b16 v[156:157], v195 offset:8192
    buffer_load_dwordx4 v200, s[20:23], s37 offen lds
    s_add_u32 s37, s37, 393216
    v_mfma_f32_16x16x32_bf16 v[28:31], v[172:175], v[132:135], v[28:31]
    ds_read_b64_tr_b16 v[158:159], v195 offset:8704
    v_mfma_f32_16x16x32_bf16 v[52:55], v[176:179], v[132:135], v[52:55]
    ds_read_b128 v[112:115], v192 offset:0
    v_mfma_f32_16x16x32_bf16 v[60:63], v[180:183], v[132:135], v[60:63]
    ds_read_b128 v[116:119], v192 offset:2048
    v_mfma_f32_16x16x32_bf16 v[88:91], v[132:135], v[184:187], v[88:91]
    ds_read_b128 v[120:123], v192 offset:4096
    v_mfma_f32_16x16x32_bf16 v[92:95], v[132:135], v[188:191], v[92:95]
    ds_read_b128 v[124:127], v192 offset:6144
    v_mfma_f32_16x16x32_bf16 v[32:35], v[168:171], v[136:139], v[32:35]
    ds_read_b64_tr_b16 v[160:161], v194 offset:16384
    v_mfma_f32_16x16x32_bf16 v[40:43], v[172:175], v[136:139], v[40:43]
    ds_read_b64_tr_b16 v[162:163], v194 offset:16896
    v_mfma_f32_16x16x32_bf16 v[64:67], v[176:179], v[136:139], v[64:67]
    ds_read_b64_tr_b16 v[164:165], v195 offset:16384
    v_mfma_f32_16x16x32_bf16 v[72:75], v[180:183], v[136:139], v[72:75]
    ds_read_b64_tr_b16 v[166:167], v195 offset:16896
    v_mfma_f32_16x16x32_bf16 v[96:99], v[136:139], v[184:187], v[96:99]
    v_mfma_f32_16x16x32_bf16 v[100:103], v[136:139], v[188:191], v[100:103]
    v_mfma_f32_16x16x32_bf16 v[36:39], v[168:171], v[140:143], v[36:39]
    s_add_u32 s85, s84, s87
    v_mfma_f32_16x16x32_bf16 v[44:47], v[172:175], v[140:143], v[44:47]
    s_cmp_eq_u32 s86, 65536
    v_mfma_f32_16x16x32_bf16 v[68:71], v[176:179], v[140:143], v[68:71]
    s_cselect_b32 s87, s89, s88
    v_mfma_f32_16x16x32_bf16 v[76:79], v[180:183], v[140:143], v[76:79]
    s_add_u32 s86, s86, s87
    v_mfma_f32_16x16x32_bf16 v[104:107], v[140:143], v[184:187], v[104:107]
    v_add_u32 v192, s87, v192
    v_mfma_f32_16x16x32_bf16 v[108:111], v[140:143], v[188:191], v[108:111]
    s_waitcnt lgkmcnt(0)
    v_mfma_f32_16x16x32_bf16 v[16:19], v[144:147], v[112:115], v[16:19]
    s_add_u32 m0, s84, 0
    ds_read_b64_tr_b16 v[168:169], v194 offset:4096
    buffer_load_dwordx4 v196, s[8:11], s36 offen lds
    v_mfma_f32_16x16x32_bf16 v[24:27], v[148:151], v[112:115], v[24:27]
    ds_read_b64_tr_b16 v[170:171], v194 offset:4608
    v_mfma_f32_16x16x32_bf16 v[48:51], v[152:155], v[112:115], v[48:51]
    ds_read_b64_tr_b16 v[172:173], v195 offset:4096
    v_mfma_f32_16x16x32_bf16 v[56:59], v[156:159], v[112:115], v[56:59]
    ds_read_b64_tr_b16 v[174:175], v195 offset:4608
    v_mfma_f32_16x16x32_bf16 v[80:83], v[112:115], v[160:163], v[80:83]
    s_add_u32 m0, s84, 1024
    ds_read_b64_tr_b16 v[176:177], v194 offset:12288
    buffer_load_dwordx4 v197, s[8:11], s36 offen lds
    v_mfma_f32_16x16x32_bf16 v[84:87], v[112:115], v[164:167], v[84:87]
    ds_read_b64_tr_b16 v[178:179], v194 offset:12800
    v_mfma_f32_16x16x32_bf16 v[20:23], v[144:147], v[116:119], v[20:23]
    ds_read_b64_tr_b16 v[180:181], v195 offset:12288
    v_mfma_f32_16x16x32_bf16 v[28:31], v[148:151], v[116:119], v[28:31]
    ds_read_b64_tr_b16 v[182:183], v195 offset:12800
    v_mfma_f32_16x16x32_bf16 v[52:55], v[152:155], v[116:119], v[52:55]
    s_add_u32 m0, s84, 2048
    ds_read_b128 v[128:131], v193 offset:0
    buffer_load_dwordx4 v198, s[8:11], s36 offen lds
    v_mfma_f32_16x16x32_bf16 v[60:63], v[156:159], v[116:119], v[60:63]
    ds_read_b128 v[132:135], v193 offset:2048
    v_mfma_f32_16x16x32_bf16 v[88:91], v[116:119], v[160:163], v[88:91]
    ds_read_b128 v[136:139], v193 offset:4096
    v_mfma_f32_16x16x32_bf16 v[92:95], v[116:119], v[164:167], v[92:95]
    ds_read_b128 v[140:143], v193 offset:6144
    v_mfma_f32_16x16x32_bf16 v[32:35], v[144:147], v[120:123], v[32:35]
    s_add_u32 m0, s84, 3072
    ds_read_b64_tr_b16 v[184:185], v194 offset:20480
    buffer_load_dwordx4 v199, s[8:11], s36 offen lds
    s_add_u32 s36, s36, 128
    s_mov_b32 s84, s85
    v_mfma_f32_16x16x32_bf16 v[40:43], v[148:151], v[120:123], v[40:43]
    ds_read_b64_tr_b16 v[186:187], v194 offset:20992
    v_mfma_f32_16x16x32_bf16 v[64:67], v[152:155], v[120:123], v[64:67]
    ds_read_b64_tr_b16 v[188:189], v195 offset:20480
    v_mfma_f32_16x16x32_bf16 v[72:75], v[156:159], v[120:123], v[72:75]
    ds_read_b64_tr_b16 v[190:191], v195 offset:20992
    v_mfma_f32_16x16x32_bf16 v[96:99], v[120:123], v[160:163], v[96:99]
    v_mfma_f32_16x16x32_bf16 v[100:103], v[120:123], v[164:167], v[100:103]
    v_mfma_f32_16x16x32_bf16 v[36:39], v[144:147], v[124:127], v[36:39]
    buffer_load_dword v202, v204, s[56:59], s90 offen
    v_mfma_f32_16x16x32_bf16 v[44:47], v[148:151], v[124:127], v[44:47]
    v_mfma_f32_16x16x32_bf16 v[68:71], v[152:155], v[124:127], v[68:71]
    v_mfma_f32_16x16x32_bf16 v[76:79], v[156:159], v[124:127], v[76:79]
    s_add_u32 s90, s90, s91
    v_mfma_f32_16x16x32_bf16 v[104:107], v[124:127], v[160:163], v[104:107]
    v_add_u32 v193, s87, v193
    v_mfma_f32_16x16x32_bf16 v[108:111], v[124:127], v[164:167], v[108:111]
    s_min_u32 s90, s90, s92
    s_waitcnt vmcnt(5) lgkmcnt(0)
    s_barrier
    v_mfma_f32_16x16x32_bf16 v[16:19], v[168:171], v[128:131], v[16:19]
    s_add_u32 m0, s40, 0
    ds_read_b64_tr_b16 v[144:145], v194 offset:24576
    buffer_load_dwordx4 v200, s[12:15], s37 offen lds
    v_mfma_f32_16x16x32_bf16 v[24:27], v[172:175], v[128:131], v[24:27]
    ds_read_b64_tr_b16 v[146:147], v194 offset:25088
    v_mfma_f32_16x16x32_bf16 v[48:51], v[176:179], v[128:131], v[48:51]
    ds_read_b64_tr_b16 v[148:149], v195 offset:24576
    v_mfma_f32_16x16x32_bf16 v[56:59], v[180:183], v[128:131], v[56:59]
    s_add_u32 m0, s40, 8192
    ds_read_b64_tr_b16 v[150:151], v195 offset:25088
    buffer_load_dwordx4 v200, s[16:19], s37 offen lds
    v_mfma_f32_16x16x32_bf16 v[80:83], v[128:131], v[184:187], v[80:83]
    ds_read_b64_tr_b16 v[152:153], v194 offset:32768
    v_mfma_f32_16x16x32_bf16 v[84:87], v[128:131], v[188:191], v[84:87]
    ds_read_b64_tr_b16 v[154:155], v194 offset:33280
    v_mfma_f32_16x16x32_bf16 v[20:23], v[168:171], v[132:135], v[20:23]
    s_add_u32 m0, s40, 16384
    ds_read_b64_tr_b16 v[156:157], v195 offset:32768
    buffer_load_dwordx4 v200, s[20:23], s37 offen lds
    s_add_u32 s37, s37, 393216
    v_mfma_f32_16x16x32_bf16 v[28:31], v[172:175], v[132:135], v[28:31]
    ds_read_b64_tr_b16 v[158:159], v195 offset:33280
    v_mfma_f32_16x16x32_bf16 v[52:55], v[176:179], v[132:135], v[52:55]
    ds_read_b128 v[112:115], v192 offset:0
    v_mfma_f32_16x16x32_bf16 v[60:63], v[180:183], v[132:135], v[60:63]
    ds_read_b128 v[116:119], v192 offset:2048
    v_mfma_f32_16x16x32_bf16 v[88:91], v[132:135], v[184:187], v[88:91]
    ds_read_b128 v[120:123], v192 offset:4096
    v_mfma_f32_16x16x32_bf16 v[92:95], v[132:135], v[188:191], v[92:95]
    ds_read_b128 v[124:127], v192 offset:6144
    v_mfma_f32_16x16x32_bf16 v[32:35], v[168:171], v[136:139], v[32:35]
    ds_read_b64_tr_b16 v[160:161], v194 offset:40960
    v_mfma_f32_16x16x32_bf16 v[40:43], v[172:175], v[136:139], v[40:43]
    ds_read_b64_tr_b16 v[162:163], v194 offset:41472
    v_mfma_f32_16x16x32_bf16 v[64:67], v[176:179], v[136:139], v[64:67]
    ds_read_b64_tr_b16 v[164:165], v195 offset:40960
    v_mfma_f32_16x16x32_bf16 v[72:75], v[180:183], v[136:139], v[72:75]
    ds_read_b64_tr_b16 v[166:167], v195 offset:41472
    v_mfma_f32_16x16x32_bf16 v[96:99], v[136:139], v[184:187], v[96:99]
    v_mfma_f32_16x16x32_bf16 v[100:103], v[136:139], v[188:191], v[100:103]
    v_mfma_f32_16x16x32_bf16 v[36:39], v[168:171], v[140:143], v[36:39]
    s_add_u32 s85, s84, s87
    v_mfma_f32_16x16x32_bf16 v[44:47], v[172:175], v[140:143], v[44:47]
    s_cmp_eq_u32 s86, 65536
    v_mfma_f32_16x16x32_bf16 v[68:71], v[176:179], v[140:143], v[68:71]
    s_cselect_b32 s87, s89, s88
    v_mfma_f32_16x16x32_bf16 v[76:79], v[180:183], v[140:143], v[76:79]
    s_add_u32 s86, s86, s87
    v_mfma_f32_16x16x32_bf16 v[104:107], v[140:143], v[184:187], v[104:107]
    v_add_u32 v192, s87, v192
    v_mfma_f32_16x16x32_bf16 v[108:111], v[140:143], v[188:191], v[108:111]
    s_sub_u32 s38, s38, 1
    s_cmp_lg_u32 s38, 0
    s_cbranch_scc1 K1_LOOP
    s_waitcnt lgkmcnt(0)
    v_mfma_f32_16x16x32_bf16 v[16:19], v[144:147], v[112:115], v[16:19]
    s_add_u32 m0, s84, 0
    ds_read_b64_tr_b16 v[168:169], v194 offset:28672
    buffer_load_dwordx4 v196, s[8:11], s36 offen lds
    v_mfma_f32_16x16x32_bf16 v[24:27], v[148:151], v[112:115], v[24:27]
    ds_read_b64_tr_b16 v[170:171], v194 offset:29184
    v_mfma_f32_16x16x32_bf16 v[48:51], v[152:155], v[112:115], v[48:51]
    ds_read_b64_tr_b16 v[172:173], v195 offset:28672
    v_mfma_f32_16x16x32_bf16 v[56:59], v[156:159], v[112:115], v[56:59]
    ds_read_b64_tr_b16 v[174:175], v195 offset:29184
    v_mfma_f32_16x16x32_bf16 v[80:83], v[112:115], v[160:163], v[80:83]
    s_add_u32 m0, s84, 1024
    ds_read_b64_tr_b16 v[176:177], v194 offset:36864
    buffer_load_dwordx4 v197, s[8:11], s36 offen lds
    v_mfma_f32_16x16x32_bf16 v[84:87], v[112:115], v[164:167], v[84:87]
    ds_read_b64_tr_b16 v[178:179], v194 offset:37376
    v_mfma_f32_16x16x32_bf16 v[20:23], v[144:147], v[116:119], v[20:23]
    ds_read_b64_tr_b16 v[180:181], v195 offset:36864
    v_mfma_f32_16x16x32_bf16 v[28:31], v[148:151], v[116:119], v[28:31]
    ds_read_b64_tr_b16 v[182:183], v195 offset:37376
    v_mfma_f32_16x16x32_bf16 v[52:55], v[152:155], v[116:119], v[52:55]
    s_add_u32 m0, s84, 2048
    ds_read_b128 v[128:131], v193 offset:0
    buffer_load_dwordx4 v198, s[8:11], s36 offen lds
    v_mfma_f32_16x16x32_bf16 v[60:63], v[156:159], v[116:119], v[60:63]
    ds_read_b128 v[132:135], v193 offset:2048
    v_mfma_f32_16x16x32_bf16 v[88:91], v[116:119], v[160:163], v[88:91]
    ds_read_b128 v[136:139], v193 offset:4096
    v_mfma_f32_16x16x32_bf16 v[92:95], v[116:119], v[164:167], v[92:95]
    ds_read_b128 v[140:143], v193 offset:6144
    v_mfma_f32_16x16x32_bf16 v[32:35], v[144:147], v[120:123], v[32:35]
    s_add_u32 m0, s84, 3072
    ds_read_b64_tr_b16 v[184:185], v194 offset:45056
    buffer_load_dwordx4 v199, s[8:11], s36 offen lds
    s_add_u32 s36, s36, 128
    s_mov_b32 s84, s85
    v_mfma_f32_16x16x32_bf16 v[40:43], v[148:151], v[120:123], v[40:43]
    ds_read_b64_tr_b16 v[186:187], v194 offset:45568
    v_mfma_f32_16x16x32_bf16 v[64:67], v[152:155], v[120:123], v[64:67]
    ds_read_b64_tr_b16 v[188:189], v195 offset:45056
    v_mfma_f32_16x16x32_bf16 v[72:75], v[156:159], v[120:123], v[72:75]
    ds_read_b64_tr_b16 v[190:191], v195 offset:45568
    v_mfma_f32_16x16x32_bf16 v[96:99], v[120:123], v[160:163], v[96:99]
    v_mfma_f32_16x16x32_bf16 v[100:103], v[120:123], v[164:167], v[100:103]
    v_mfma_f32_16x16x32_bf16 v[36:39], v[144:147], v[124:127], v[36:39]
    buffer_load_dword v202, v204, s[56:59], s90 offen
    v_mfma_f32_16x16x32_bf16 v[44:47], v[148:151], v[124:127], v[44:47]
    v_mfma_f32_16x16x32_bf16 v[68:71], v[152:155], v[124:127], v[68:71]
    v_mfma_f32_16x16x32_bf16 v[76:79], v[156:159], v[124:127], v[76:79]
    s_add_u32 s90, s90, s91
    v_mfma_f32_16x16x32_bf16 v[104:107], v[124:127], v[160:163], v[104:107]
    v_add_u32 v193, s87, v193
    v_mfma_f32_16x16x32_bf16 v[108:111], v[124:127], v[164:167], v[108:111]
    s_min_u32 s90, s90, s92
    s_waitcnt vmcnt(5) lgkmcnt(0)
    s_barrier
    v_mfma_f32_16x16x32_bf16 v[16:19], v[168:171], v[128:131], v[16:19]
    s_add_u32 m0, s40, 24576
    ds_read_b64_tr_b16 v[144:145], v194 offset:0
    buffer_load_dwordx4 v200, s[12:15], s37 offen lds
    v_mfma_f32_16x16x32_bf16 v[24:27], v[172:175], v[128:131], v[24:27]
    ds_read_b64_tr_b16 v[146:147], v194 offset:512
    v_mfma_f32_16x16x32_bf16 v[48:51], v[176:179], v[128:131], v[48:51]
    ds_read_b64_tr_b16 v[148:149], v195 offset:0
    v_mfma_f32_16x16x32_bf16 v[56:59], v[180:183], v[128:131], v[56:59]
    s_add_u32 m0, s40, 32768
    ds_read_b64_tr_b16 v[150:151], v195 offset:512
    buffer_load_dwordx4 v200, s[16:19], s37 offen lds
    v_mfma_f32_16x16x32_bf16 v[80:83], v[128:131], v[184:187], v[80:83]
    ds_read_b64_tr_b16 v[152:153], v194 offset:8192
    v_mfma_f32_16x16x32_bf16 v[84:87], v[128:131], v[188:191], v[84:87]
    ds_read_b64_tr_b16 v[154:155], v194 offset:8704
    v_mfma_f32_16x16x32_bf16 v[20:23], v[168:171], v[132:135], v[20:23]
    s_add_u32 m0, s40, 40960
    ds_read_b64_tr_b16 v[156:157], v195 offset:8192
    buffer_load_dwordx4 v200, s[20:23], s37 offen lds
    s_add_u32 s37, s37, 393216
    v_mfma_f32_16x16x32_bf16 v[28:31], v[172:175], v[132:135], v[28:31]
    ds_read_b64_tr_b16 v[158:159], v195 offset:8704
    v_mfma_f32_16x16x32_bf16 v[52:55], v[176:179], v[132:135], v[52:55]
    ds_read_b128 v[112:115], v192 offset:0
    v_mfma_f32_16x16x32_bf16 v[60:63], v[180:183], v[132:135], v[60:63]
    ds_read_b128 v[116:119], v192 offset:2048
    v_mfma_f32_16x16x32_bf16 v[88:91], v[132:135], v[184:187], v[88:91]
    ds_read_b128 v[120:123], v192 offset:4096
    v_mfma_f32_16x16x32_bf16 v[92:95], v[132:135], v[188:191], v[92:95]
    ds_read_b128 v[124:127], v192 offset:6144
    v_mfma_f32_16x16x32_bf16 v[32:35], v[168:171], v[136:139], v[32:35]
    ds_read_b64_tr_b16 v[160:161], v194 offset:16384
    v_mfma_f32_16x16x32_bf16 v[40:43], v[172:175], v[136:139], v[40:43]
    ds_read_b64_tr_b16 v[162:163], v194 offset:16896
    v_mfma_f32_16x16x32_bf16 v[64:67], v[176:179], v[136:139], v[64:67]
    ds_read_b64_tr_b16 v[164:165], v195 offset:16384
    v_mfma_f32_16x16x32_bf16 v[72:75], v[180:183], v[136:139], v[72:75]
    ds_read_b64_tr_b16 v[166:167], v195 offset:16896
    v_mfma_f32_16x16x32_bf16 v[96:99], v[136:139], v[184:187], v[96:99]
    v_mfma_f32_16x16x32_bf16 v[100:103], v[136:139], v[188:191], v[100:103]
    v_mfma_f32_16x16x32_bf16 v[36:39], v[168:171], v[140:143], v[36:39]
    v_mfma_f32_16x16x32_bf16 v[44:47], v[172:175], v[140:143], v[44:47]
    s_cmp_eq_u32 s86, 65536
    v_mfma_f32_16x16x32_bf16 v[68:71], v[176:179], v[140:143], v[68:71]
    s_cselect_b32 s87, s89, s88
    v_mfma_f32_16x16x32_bf16 v[76:79], v[180:183], v[140:143], v[76:79]
    s_add_u32 s86, s86, s87
    v_mfma_f32_16x16x32_bf16 v[104:107], v[140:143], v[184:187], v[104:107]
    v_add_u32 v192, s87, v192
    v_mfma_f32_16x16x32_bf16 v[108:111], v[140:143], v[188:191], v[108:111]
    v_lshlrev_b32 v2, 5, v1
    s_lshl_b32 s43, s54, 11
    s_waitcnt lgkmcnt(0)
    v_mfma_f32_16x16x32_bf16 v[16:19], v[144:147], v[112:115], v[16:19]
    ds_read_b64_tr_b16 v[168:169], v194 offset:4096
    v_mfma_f32_16x16x32_bf16 v[24:27], v[148:151], v[112:115], v[24:27]
    ds_read_b64_tr_b16 v[170:171], v194 offset:4608
    v_mfma_f32_16x16x32_bf16 v[48:51], v[152:155], v[112:115], v[48:51]
    ds_read_b64_tr_b16 v[172:173], v195 offset:4096
    v_mfma_f32_16x16x32_bf16 v[56:59], v[156:159], v[112:115], v[56:59]
    ds_read_b64_tr_b16 v[174:175], v195 offset:4608
    v_mfma_f32_16x16x32_bf16 v[80:83], v[112:115], v[160:163], v[80:83]
    ds_read_b64_tr_b16 v[176:177], v194 offset:12288
    v_mfma_f32_16x16x32_bf16 v[84:87], v[112:115], v[164:167], v[84:87]
    ds_read_b64_tr_b16 v[178:179], v194 offset:12800
    v_mfma_f32_16x16x32_bf16 v[20:23], v[144:147], v[116:119], v[20:23]
    ds_read_b64_tr_b16 v[180:181], v195 offset:12288
    v_mfma_f32_16x16x32_bf16 v[28:31], v[148:151], v[116:119], v[28:31]
    ds_read_b64_tr_b16 v[182:183], v195 offset:12800
    v_mfma_f32_16x16x32_bf16 v[52:55], v[152:155], v[116:119], v[52:55]
    ds_read_b128 v[128:131], v193 offset:0
    v_mfma_f32_16x16x32_bf16 v[60:63], v[156:159], v[116:119], v[60:63]
    ds_read_b128 v[132:135], v193 offset:2048
    v_mfma_f32_16x16x32_bf16 v[88:91], v[116:119], v[160:163], v[88:91]
    ds_read_b128 v[136:139], v193 offset:4096
    v_mfma_f32_16x16x32_bf16 v[92:95], v[116:119], v[164:167], v[92:95]
    ds_read_b128 v[140:143], v193 offset:6144
    v_mfma_f32_16x16x32_bf16 v[32:35], v[144:147], v[120:123], v[32:35]
    ds_read_b64_tr_b16 v[184:185], v194 offset:20480
    v_mfma_f32_16x16x32_bf16 v[40:43], v[148:151], v[120:123], v[40:43]
    ds_read_b64_tr_b16 v[186:187], v194 offset:20992
    v_mfma_f32_16x16x32_bf16 v[64:67], v[152:155], v[120:123], v[64:67]
    ds_read_b64_tr_b16 v[188:189], v195 offset:20480
    v_mfma_f32_16x16x32_bf16 v[72:75], v[156:159], v[120:123], v[72:75]
    ds_read_b64_tr_b16 v[190:191], v195 offset:20992
    v_mfma_f32_16x16x32_bf16 v[96:99], v[120:123], v[160:163], v[96:99]
    v_mfma_f32_16x16x32_bf16 v[100:103], v[120:123], v[164:167], v[100:103]
    buffer_load_dwordx4 v[206:209], v2, s[8:11], s43 offen offset:0
    v_mfma_f32_16x16x32_bf16 v[36:39], v[144:147], v[124:127], v[36:39]
    v_mfma_f32_16x16x32_bf16 v[44:47], v[148:151], v[124:127], v[44:47]
    buffer_load_dwordx4 v[210:213], v2, s[8:11], s43 offen offset:16
    v_mfma_f32_16x16x32_bf16 v[68:71], v[152:155], v[124:127], v[68:71]
    buffer_load_dwordx4 v[214:217], v2, s[28:31], 0 offen offset:0
    v_mfma_f32_16x16x32_bf16 v[76:79], v[156:159], v[124:127], v[76:79]
    v_mfma_f32_16x16x32_bf16 v[104:107], v[124:127], v[160:163], v[104:107]
    v_add_u32 v193, s87, v193
    buffer_load_dwordx4 v[218:221], v2, s[28:31], 0 offen offset:16
    v_mfma_f32_16x16x32_bf16 v[108:111], v[124:127], v[164:167], v[108:111]
    ds_write_b32 v253, v14 offset:65472
    s_waitcnt vmcnt(4) lgkmcnt(0)
    s_barrier
    v_mfma_f32_16x16x32_bf16 v[16:19], v[168:171], v[128:131], v[16:19]
    ds_read_b64_tr_b16 v[144:145], v194 offset:24576
    v_mfma_f32_16x16x32_bf16 v[24:27], v[172:175], v[128:131], v[24:27]
    ds_read_b64_tr_b16 v[146:147], v194 offset:25088
    v_mfma_f32_16x16x32_bf16 v[48:51], v[176:179], v[128:131], v[48:51]
    ds_read_b64_tr_b16 v[148:149], v195 offset:24576
    v_mfma_f32_16x16x32_bf16 v[56:59], v[180:183], v[128:131], v[56:59]
    ds_read_b64_tr_b16 v[150:151], v195 offset:25088
    v_mfma_f32_16x16x32_bf16 v[80:83], v[128:131], v[184:187], v[80:83]
    ds_read_b64_tr_b16 v[152:153], v194 offset:32768
    v_mfma_f32_16x16x32_bf16 v[84:87], v[128:131], v[188:191], v[84:87]
    ds_read_b64_tr_b16 v[154:155], v194 offset:33280
    v_mfma_f32_16x16x32_bf16 v[20:23], v[168:171], v[132:135], v[20:23]
    ds_read_b64_tr_b16 v[156:157], v195 offset:32768
    v_mfma_f32_16x16x32_bf16 v[28:31], v[172:175], v[132:135], v[28:31]
    ds_read_b64_tr_b16 v[158:159], v195 offset:33280
    v_mfma_f32_16x16x32_bf16 v[52:55], v[176:179], v[132:135], v[52:55]
    ds_read_b128 v[112:115], v192 offset:0
    v_mfma_f32_16x16x32_bf16 v[60:63], v[180:183], v[132:135], v[60:63]
    ds_read_b128 v[116:119], v192 offset:2048
    v_mfma_f32_16x16x32_bf16 v[88:91], v[132:135], v[184:187], v[88:91]
    ds_read_b128 v[120:123], v192 offset:4096
    v_mfma_f32_16x16x32_bf16 v[92:95], v[132:135], v[188:191], v[92:95]
    ds_read_b128 v[124:127], v192 offset:6144
    v_mfma_f32_16x16x32_bf16 v[32:35], v[168:171], v[136:139], v[32:35]
    ds_read_b64_tr_b16 v[160:161], v194 offset:40960
    v_mfma_f32_16x16x32_bf16 v[40:43], v[172:175], v[136:139], v[40:43]
    ds_read_b64_tr_b16 v[162:163], v194 offset:41472
    v_mfma_f32_16x16x32_bf16 v[64:67], v[176:179], v[136:139], v[64:67]
    ds_read_b64_tr_b16 v[164:165], v195 offset:40960
    v_mfma_f32_16x16x32_bf16 v[72:75], v[180:183], v[136:139], v[72:75]
    ds_read_b64_tr_b16 v[166:167], v195 offset:41472
    v_mfma_f32_16x16x32_bf16 v[96:99], v[136:139], v[184:187], v[96:99]
    v_mfma_f32_16x16x32_bf16 v[100:103], v[136:139], v[188:191], v[100:103]
    v_mfma_f32_16x16x32_bf16 v[36:39], v[168:171], v[140:143], v[36:39]
    v_mfma_f32_16x16x32_bf16 v[44:47], v[172:175], v[140:143], v[44:47]
    v_mfma_f32_16x16x32_bf16 v[68:71], v[176:179], v[140:143], v[68:71]
    v_mfma_f32_16x16x32_bf16 v[76:79], v[180:183], v[140:143], v[76:79]
    v_mfma_f32_16x16x32_bf16 v[104:107], v[140:143], v[184:187], v[104:107]
    v_mfma_f32_16x16x32_bf16 v[108:111], v[140:143], v[188:191], v[108:111]
    s_waitcnt lgkmcnt(0)
    v_mfma_f32_16x16x32_bf16 v[16:19], v[144:147], v[112:115], v[16:19]
    ds_read_b64_tr_b16 v[168:169], v194 offset:28672
    v_mfma_f32_16x16x32_bf16 v[24:27], v[148:151], v[112:115], v[24:27]
    ds_read_b64_tr_b16 v[170:171], v194 offset:29184
    v_mfma_f32_16x16x32_bf16 v[48:51], v[152:155], v[112:115], v[48:51]
    ds_read_b64_tr_b16 v[172:173], v195 offset:28672
    v_mfma_f32_16x16x32_bf16 v[56:59], v[156:159], v[112:115], v[56:59]
    ds_read_b64_tr_b16 v[174:175], v195 offset:29184
    v_mfma_f32_16x16x32_bf16 v[80:83], v[112:115], v[160:163], v[80:83]
    ds_read_b64_tr_b16 v[176:177], v194 offset:36864
    v_mfma_f32_16x16x32_bf16 v[84:87], v[112:115], v[164:167], v[84:87]
    ds_read_b64_tr_b16 v[178:179], v194 offset:37376
    v_mfma_f32_16x16x32_bf16 v[20:23], v[144:147], v[116:119], v[20:23]
    ds_read_b64_tr_b16 v[180:181], v195 offset:36864
    v_mfma_f32_16x16x32_bf16 v[28:31], v[148:151], v[116:119], v[28:31]
    ds_read_b64_tr_b16 v[182:183], v195 offset:37376
    v_mfma_f32_16x16x32_bf16 v[52:55], v[152:155], v[116:119], v[52:55]
    ds_read_b128 v[128:131], v193 offset:0
    v_mfma_f32_16x16x32_bf16 v[60:63], v[156:159], v[116:119], v[60:63]
    ds_read_b128 v[132:135], v193 offset:2048
    s_waitcnt vmcnt(0)
    v_mfma_f32_16x16x32_bf16 v[88:91], v[116:119], v[160:163], v[88:91]
    ds_read_b128 v[136:139], v193 offset:4096
    v_dot2_f32_bf16 v222, v206, v214, 0
    v_mfma_f32_16x16x32_bf16 v[92:95], v[116:119], v[164:167], v[92:95]
    ds_read_b128 v[140:143], v193 offset:6144
    v_dot2_f32_bf16 v223, v207, v215, 0
    v_mfma_f32_16x16x32_bf16 v[32:35], v[144:147], v[120:123], v[32:35]
    ds_read_b64_tr_b16 v[184:185], v194 offset:45056
    v_dot2_f32_bf16 v222, v208, v216, v222
    v_mfma_f32_16x16x32_bf16 v[40:43], v[148:151], v[120:123], v[40:43]
    ds_read_b64_tr_b16 v[186:187], v194 offset:45568
    v_mfma_f32_16x16x32_bf16 v[64:67], v[152:155], v[120:123], v[64:67]
    ds_read_b64_tr_b16 v[188:189], v195 offset:45056
    v_dot2_f32_bf16 v223, v209, v217, v223
    v_mfma_f32_16x16x32_bf16 v[72:75], v[156:159], v[120:123], v[72:75]
    ds_read_b64_tr_b16 v[190:191], v195 offset:45568
    v_dot2_f32_bf16 v222, v210, v218, v222
    v_mfma_f32_16x16x32_bf16 v[96:99], v[120:123], v[160:163], v[96:99]
    v_dot2_f32_bf16 v223, v211, v219, v223
    v_mfma_f32_16x16x32_bf16 v[100:103], v[120:123], v[164:167], v[100:103]
    v_dot2_f32_bf16 v222, v212, v220, v222
    v_mfma_f32_16x16x32_bf16 v[36:39], v[144:147], v[124:127], v[36:39]
    v_mfma_f32_16x16x32_bf16 v[44:47], v[148:151], v[124:127], v[44:47]
    v_dot2_f32_bf16 v223, v213, v221, v223
    v_mfma_f32_16x16x32_bf16 v[68:71], v[152:155], v[124:127], v[68:71]
    s_nop 1
    v_add_f32 v222, v222, v223
    v_mfma_f32_16x16x32_bf16 v[76:79], v[156:159], v[124:127], v[76:79]
    s_nop 0
    v_add_f32_dpp v222, v222, v222 quad_perm:[1,0,3,2] row_mask:0xf bank_mask:0xf
    v_mfma_f32_16x16x32_bf16 v[104:107], v[124:127], v[160:163], v[104:107]
    s_nop 0
    v_add_f32_dpp v222, v222, v222 quad_perm:[2,3,0,1] row_mask:0xf bank_mask:0xf
    v_mfma_f32_16x16x32_bf16 v[108:111], v[124:127], v[164:167], v[108:111]
    s_nop 0
    v_add_f32_dpp v222, v222, v222 row_half_mirror row_mask:0xf bank_mask:0xf
    s_waitcnt lgkmcnt(0)
    s_barrier
    v_mfma_f32_16x16x32_bf16 v[16:19], v[168:171], v[128:131], v[16:19]
    ds_read_b64_tr_b16 v[236:237], v203 offset:0
    v_mfma_f32_16x16x32_bf16 v[24:27], v[172:175], v[128:131], v[24:27]
    ds_read_b64_tr_b16 v[238:239], v203 offset:256
    v_add_f32_dpp v222, v222, v222 row_mirror row_mask:0xf bank_mask:0xf
    v_mfma_f32_16x16x32_bf16 v[48:51], v[176:179], v[128:131], v[48:51]
    ds_read_b64_tr_b16 v[240:241], v203 offset:1024
    v_mov_b32 v223, v222
    v_mfma_f32_16x16x32_bf16 v[56:59], v[180:183], v[128:131], v[56:59]
    ds_read_b64_tr_b16 v[242:243], v203 offset:1280
    v_mfma_f32_16x16x32_bf16 v[80:83], v[128:131], v[184:187], v[80:83]
    v_permlane16_swap_b32 v222, v223
    v_mfma_f32_16x16x32_bf16 v[84:87], v[128:131], v[188:191], v[84:87]
    v_add_f32 v222, v222, v223
    v_mfma_f32_16x16x32_bf16 v[20:23], v[168:171], v[132:135], v[20:23]
    v_mfma_f32_16x16x32_bf16 v[28:31], v[172:175], v[132:135], v[28:31]
    v_mov_b32 v223, v222
    v_mfma_f32_16x16x32_bf16 v[52:55], v[176:179], v[132:135], v[52:55]
    s_nop 0
    v_permlane32_swap_b32 v222, v223
    v_mfma_f32_16x16x32_bf16 v[60:63], v[180:183], v[132:135], v[60:63]
    v_mfma_f32_16x16x32_bf16 v[88:91], v[132:135], v[184:187], v[88:91]
    v_add_f32 v222, v222, v223
    v_mfma_f32_16x16x32_bf16 v[92:95], v[132:135], v[188:191], v[92:95]
    v_cvt_pk_bf16_f32 v222, v222, v222
    v_mfma_f32_16x16x32_bf16 v[32:35], v[168:171], v[136:139], v[32:35]
    v_mfma_f32_16x16x32_bf16 v[40:43], v[172:175], v[136:139], v[40:43]
    v_lshlrev_b32 v222, 16, v222
    v_mfma_f32_16x16x32_bf16 v[64:67], v[176:179], v[136:139], v[64:67]
    v_mul_f32 v222, 0xbfb8aa3b, v222
    v_mfma_f32_16x16x32_bf16 v[72:75], v[180:183], v[136:139], v[72:75]
    v_mfma_f32_16x16x32_bf16 v[96:99], v[136:139], v[184:187], v[96:99]
    v_exp_f32 v222, v222
    v_mfma_f32_16x16x32_bf16 v[100:103], v[136:139], v[188:191], v[100:103]
    v_add_f32 v222, 1.0, v222
    v_mfma_f32_16x16x32_bf16 v[36:39], v[168:171], v[140:143], v[36:39]
    v_mfma_f32_16x16x32_bf16 v[44:47], v[172:175], v[140:143], v[44:47]
    v_rcp_f32 v222, v222
    v_mfma_f32_16x16x32_bf16 v[68:71], v[176:179], v[140:143], v[68:71]
    v_cvt_pk_bf16_f32 v222, v222, v222
    v_mfma_f32_16x16x32_bf16 v[76:79], v[180:183], v[140:143], v[76:79]
    v_mfma_f32_16x16x32_bf16 v[104:107], v[140:143], v[184:187], v[104:107]
    v_lshlrev_b32 v222, 16, v222
    v_mfma_f32_16x16x32_bf16 v[108:111], v[140:143], v[188:191], v[108:111]
    v_mov_b32 v223, 0
    s_lshl_b32 s57, s54, 2
    s_add_u32 s57, s57, 23592960
    buffer_store_dword v222, v223, s[24:27], s57 offen sc1
    s_cmp_lg_u32 s32, 0
    s_cbranch_scc1 M_NC
    s_mov_b32 s96, s94
    s_mov_b32 s97, s95
    s_mov_b32 s98, 0x100
    s_mov_b32 s99, 0x20000
    buffer_load_dword v252, v253, s[96:99], 0 offen sc1
M_NC:
    s_waitcnt lgkmcnt(0)
    s_cmp_lg_u32 s33, 0
    s_cbranch_scc1 K1_BETA
    s_lshl_b32 s56, s42, 12
    s_add_u32 s57, s56, 4194304
    s_add_u32 s58, s57, 4096
    v_cvt_pk_bf16_f32 v48, v48, v49
    v_cvt_pk_bf16_f32 v49, v50, v51
    v_cvt_pk_bf16_f32 v50, v52, v53
    v_cvt_pk_bf16_f32 v51, v54, v55
    v_cvt_pk_bf16_f32 v52, v56, v57
    v_permlane16_swap_b32 v48, v50
    v_permlane16_swap_b32 v49, v51
    v_cvt_pk_bf16_f32 v53, v58, v59
    v_cvt_pk_bf16_f32 v54, v60, v61
    v_cvt_pk_bf16_f32 v55, v62, v63
    buffer_store_dwordx4 v[48:51], v15, s[24:27], s57 offen offset:0 sc1
    v_permlane16_swap_b32 v52, v54
    v_permlane16_swap_b32 v53, v55
    v_cvt_pk_bf16_f32 v112, v16, v17
    v_cvt_pk_bf16_f32 v113, v18, v19
    v_cvt_pk_bf16_f32 v114, v20, v21
    v_cvt_pk_bf16_f32 v115, v22, v23
    v_cvt_pk_bf16_f32 v116, v24, v25
    v_cvt_pk_bf16_f32 v117, v26, v27
    v_cvt_pk_bf16_f32 v118, v28, v29
    buffer_store_dwordx4 v[52:55], v15, s[24:27], s57 offen offset:1024 sc1
    v_cvt_pk_bf16_f32 v119, v30, v31
    v_permlane16_swap_b32 v112, v114
    v_permlane16_swap_b32 v113, v115
    v_cvt_pk_bf16_f32 v120, v32, v33
    v_cvt_pk_bf16_f32 v121, v34, v35
    v_cvt_pk_bf16_f32 v122, v36, v37
    v_cvt_pk_bf16_f32 v123, v38, v39
    v_permlane16_swap_b32 v116, v118
    v_permlane16_swap_b32 v117, v119
    v_mfma_f32_32x32x16_bf16 v[16:31], v[236:239], v[112:115], 0
    v_cvt_pk_bf16_f32 v124, v40, v41
    v_cvt_pk_bf16_f32 v125, v42, v43
    v_cvt_pk_bf16_f32 v126, v44, v45
    v_cvt_pk_bf16_f32 v127, v46, v47
    v_permlane16_swap_b32 v120, v122
    v_permlane16_swap_b32 v121, v123
    v_mfma_f32_32x32x16_bf16 v[16:31], v[240:243], v[116:119], v[16:31]
    v_permlane16_swap_b32 v124, v126
    v_permlane16_swap_b32 v125, v127
    v_cvt_pk_bf16_f32 v64, v64, v65
    v_cvt_pk_bf16_f32 v65, v66, v67
    v_cvt_pk_bf16_f32 v66, v68, v69
    v_cvt_pk_bf16_f32 v67, v70, v71
    v_mfma_f32_32x32x16_bf16 v[32:47], v[236:239], v[120:123], 0
    v_permlane16_swap_b32 v64, v66
    v_permlane16_swap_b32 v65, v67
    buffer_store_dwordx4 v[64:67], v15, s[24:27], s58 offen offset:0 sc1
    v_cvt_pk_bf16_f32 v68, v72, v73
    v_cvt_pk_bf16_f32 v69, v74, v75
    v_cvt_pk_bf16_f32 v70, v76, v77
    v_mfma_f32_32x32x16_bf16 v[32:47], v[240:243], v[124:127], v[32:47]
    v_cvt_pk_bf16_f32 v71, v78, v79
    v_permlane16_swap_b32 v68, v70
    v_cvt_pk_bf16_f32 v112, v16, v17
    v_permlane16_swap_b32 v69, v71
    buffer_store_dwordx4 v[68:71], v15, s[24:27], s58 offen offset:1024 sc1
    v_cvt_pk_bf16_f32 v113, v18, v19
    v_cvt_pk_bf16_f32 v114, v20, v21
    v_cvt_pk_bf16_f32 v115, v22, v23
    v_cvt_pk_bf16_f32 v116, v24, v25
    v_cvt_pk_bf16_f32 v117, v26, v27
    v_cvt_pk_bf16_f32 v118, v28, v29
    v_cvt_pk_bf16_f32 v119, v30, v31
    v_mfma_f32_32x32x16_bf16 v[16:31], v[224:227], v[112:115], 0
    v_cvt_pk_bf16_f32 v120, v32, v33
    v_cvt_pk_bf16_f32 v121, v34, v35
    v_cvt_pk_bf16_f32 v122, v36, v37
    v_cvt_pk_bf16_f32 v123, v38, v39
    v_cvt_pk_bf16_f32 v124, v40, v41
    v_cvt_pk_bf16_f32 v125, v42, v43
    v_mfma_f32_32x32x16_bf16 v[16:31], v[228:231], v[116:119], v[16:31]
    v_cvt_pk_bf16_f32 v126, v44, v45
    v_cvt_pk_bf16_f32 v127, v46, v47
    v_cvt_pk_bf16_f32 v80, v80, v81
    v_cvt_pk_bf16_f32 v81, v82, v83
    v_cvt_pk_bf16_f32 v82, v84, v85
    v_cvt_pk_bf16_f32 v83, v86, v87
    v_mfma_f32_32x32x16_bf16 v[32:47], v[224:227], v[120:123], 0
    v_cvt_pk_bf16_f32 v84, v88, v89
    v_cvt_pk_bf16_f32 v85, v90, v91
    v_cvt_pk_bf16_f32 v86, v92, v93
    v_cvt_pk_bf16_f32 v87, v94, v95
    s_nop 0
    v_max3_f32 v116, v16, v17, v18
    v_min3_f32 v118, v16, v17, v18
    v_mfma_f32_32x32x16_bf16 v[32:47], v[228:231], v[124:127], v[32:47]
    v_max3_f32 v116, v116, v19, v20
    v_min3_f32 v118, v118, v19, v20
    v_max3_f32 v116, v116, v21, v22
    v_min3_f32 v118, v118, v21, v22
    v_max3_f32 v116, v116, v23, v24
    v_min3_f32 v118, v118, v23, v24
    v_max3_f32 v116, v116, v25, v26
    v_min3_f32 v118, v118, v25, v26
    v_max3_f32 v116, v116, v27, v28
    v_min3_f32 v118, v118, v27, v28
    v_max3_f32 v116, v116, v29, v30
    v_min3_f32 v118, v118, v29, v30
    v_max3_f32 v124, v32, v33, v34
    v_min3_f32 v126, v32, v33, v34
    v_max3_f32 v124, v124, v35, v36
    v_min3_f32 v126, v126, v35, v36
    v_max3_f32 v124, v124, v37, v38
    v_min3_f32 v126, v126, v37, v38
    v_max_f32 v116, v116, v31
    v_min_f32 v118, v118, v31
    v_max3_f32 v124, v124, v39, v40
    v_min3_f32 v126, v126, v39, v40
    v_mov_b32 v117, v116
    v_mov_b32 v119, v118
    v_max3_f32 v124, v124, v41, v42
    v_min3_f32 v126, v126, v41, v42
    v_max3_f32 v124, v124, v43, v44
    v_min3_f32 v126, v126, v43, v44
    v_max3_f32 v124, v124, v45, v46
    v_min3_f32 v126, v126, v45, v46
    v_permlane32_swap_b32 v116, v117
    v_permlane32_swap_b32 v118, v119
    v_max_f32 v124, v124, v47
    v_min_f32 v126, v126, v47
    v_max_f32 v116, v116, v117
    v_min_f32 v118, v118, v119
    v_mov_b32 v125, v124
    v_mov_b32 v127, v126
    v_mul_f32 v116, s60, v116
    v_mul_f32 v118, s60, v118
    v_pk_fma_f32 v[128:129], v[16:17], s[60:61], v[116:117] op_sel_hi:[1,0,0] neg_lo:[0,0,1] neg_hi:[0,0,1]
    v_pk_fma_f32 v[130:131], v[18:19], s[60:61], v[116:117] op_sel_hi:[1,0,0] neg_lo:[0,0,1] neg_hi:[0,0,1]
    v_pk_fma_f32 v[144:145], v[16:17], s[60:61], v[118:119] op_sel_hi:[1,0,0] neg_lo:[1,0,0] neg_hi:[1,0,0]
    v_pk_fma_f32 v[146:147], v[18:19], s[60:61], v[118:119] op_sel_hi:[1,0,0] neg_lo:[1,0,0] neg_hi:[1,0,0]
    v_pk_fma_f32 v[132:133], v[20:21], s[60:61], v[116:117] op_sel_hi:[1,0,0] neg_lo:[0,0,1] neg_hi:[0,0,1]
    v_exp_f32 v128, v128
    v_exp_f32 v129, v129
    v_exp_f32 v130, v130
    v_exp_f32 v131, v131
    v_pk_fma_f32 v[148:149], v[20:21], s[60:61], v[118:119] op_sel_hi:[1,0,0] neg_lo:[1,0,0] neg_hi:[1,0,0]
    v_exp_f32 v144, v144
    v_exp_f32 v145, v145
    v_exp_f32 v146, v146
    v_exp_f32 v147, v147
    v_permlane32_swap_b32 v124, v125
    v_permlane32_swap_b32 v126, v127
    v_pk_fma_f32 v[134:135], v[22:23], s[60:61], v[116:117] op_sel_hi:[1,0,0] neg_lo:[0,0,1] neg_hi:[0,0,1]
    v_exp_f32 v132, v132
    v_exp_f32 v133, v133
    v_pk_fma_f32 v[150:151], v[22:23], s[60:61], v[118:119] op_sel_hi:[1,0,0] neg_lo:[1,0,0] neg_hi:[1,0,0]
    v_exp_f32 v148, v148
    v_exp_f32 v149, v149
    v_max_f32 v124, v124, v125
    v_min_f32 v126, v126, v127
    v_pk_fma_f32 v[136:137], v[24:25], s[60:61], v[116:117] op_sel_hi:[1,0,0] neg_lo:[0,0,1] neg_hi:[0,0,1]
    v_exp_f32 v134, v134
    v_exp_f32 v135, v135
    v_pk_fma_f32 v[152:153], v[24:25], s[60:61], v[118:119] op_sel_hi:[1,0,0] neg_lo:[1,0,0] neg_hi:[1,0,0]
    v_exp_f32 v150, v150
    v_exp_f32 v151, v151
    v_mul_f32 v124, s60, v124
    v_mul_f32 v126, s60, v126
    v_pk_fma_f32 v[138:139], v[26:27], s[60:61], v[116:117] op_sel_hi:[1,0,0] neg_lo:[0,0,1] neg_hi:[0,0,1]
    v_exp_f32 v136, v136
    v_exp_f32 v137, v137
    v_pk_add_f32 v[112:113], v[128:129], v[130:131]
    v_pk_fma_f32 v[154:155], v[26:27], s[60:61], v[118:119] op_sel_hi:[1,0,0] neg_lo:[1,0,0] neg_hi:[1,0,0]
    v_exp_f32 v152, v152
    v_exp_f32 v153, v153
    v_pk_add_f32 v[114:115], v[144:145], v[146:147]
    v_pk_fma_f32 v[160:161], v[32:33], s[60:61], v[124:125] op_sel_hi:[1,0,0] neg_lo:[0,0,1] neg_hi:[0,0,1]
    v_pk_fma_f32 v[162:163], v[34:35], s[60:61], v[124:125] op_sel_hi:[1,0,0] neg_lo:[0,0,1] neg_hi:[0,0,1]
    v_pk_fma_f32 v[176:177], v[32:33], s[60:61], v[126:127] op_sel_hi:[1,0,0] neg_lo:[1,0,0] neg_hi:[1,0,0]
    v_pk_fma_f32 v[178:179], v[34:35], s[60:61], v[126:127] op_sel_hi:[1,0,0] neg_lo:[1,0,0] neg_hi:[1,0,0]
    v_pk_fma_f32 v[140:141], v[28:29], s[60:61], v[116:117] op_sel_hi:[1,0,0] neg_lo:[0,0,1] neg_hi:[0,0,1]
    v_exp_f32 v138, v138
    v_exp_f32 v139, v139
    v_pk_add_f32 v[112:113], v[112:113], v[132:133]
    v_pk_fma_f32 v[156:157], v[28:29], s[60:61], v[118:119] op_sel_hi:[1,0,0] neg_lo:[1,0,0] neg_hi:[1,0,0]
    v_exp_f32 v154, v154
    v_exp_f32 v155, v155
    v_pk_add_f32 v[114:115], v[114:115], v[148:149]
    v_pk_fma_f32 v[164:165], v[36:37], s[60:61], v[124:125] op_sel_hi:[1,0,0] neg_lo:[0,0,1] neg_hi:[0,0,1]
    v_exp_f32 v160, v160
    v_exp_f32 v161, v161
    v_exp_f32 v162, v162
    v_exp_f32 v163, v163
    v_pk_fma_f32 v[180:181], v[36:37], s[60:61], v[126:127] op_sel_hi:[1,0,0] neg_lo:[1,0,0] neg_hi:[1,0,0]
    v_exp_f32 v176, v176
    v_exp_f32 v177, v177
    v_exp_f32 v178, v178
    v_exp_f32 v179, v179
    v_pk_fma_f32 v[142:143], v[30:31], s[60:61], v[116:117] op_sel_hi:[1,0,0] neg_lo:[0,0,1] neg_hi:[0,0,1]
    v_exp_f32 v140, v140
    v_exp_f32 v141, v141
    v_pk_add_f32 v[112:113], v[112:113], v[134:135]
    v_pk_fma_f32 v[158:159], v[30:31], s[60:61], v[118:119] op_sel_hi:[1,0,0] neg_lo:[1,0,0] neg_hi:[1,0,0]
    v_exp_f32 v156, v156
    v_exp_f32 v157, v157
    v_pk_add_f32 v[114:115], v[114:115], v[150:151]
    v_pk_fma_f32 v[166:167], v[38:39], s[60:61], v[124:125] op_sel_hi:[1,0,0] neg_lo:[0,0,1] neg_hi:[0,0,1]
    v_exp_f32 v164, v164
    v_exp_f32 v165, v165
    v_pk_fma_f32 v[182:183], v[38:39], s[60:61], v[126:127] op_sel_hi:[1,0,0] neg_lo:[1,0,0] neg_hi:[1,0,0]
    s_waitcnt vmcnt(0)
    s_cmp_lg_u32 s32, 0
    s_cbranch_scc1 M_Ealpha
    v_cmp_ne_u32 vcc, 1, v252
    s_cbranch_vccnz M_LSPINalpha
M_LOKalpha:
M_Ealpha:
    s_mov_b64 exec, 1
    ds_add_rtn_u32 v252, v253, v255 offset:65472
    s_mov_b64 exec, -1
    s_mov_b32 s88, -1
    s_mov_b32 s89, 0xffff
    v_exp_f32 v180, v180
    v_exp_f32 v181, v181
    v_exp_f32 v142, v142
    v_exp_f32 v143, v143
    v_pk_add_f32 v[112:113], v[112:113], v[136:137]
    v_exp_f32 v158, v158
    v_exp_f32 v159, v159
    v_pk_add_f32 v[114:115], v[114:115], v[152:153]
    v_pk_fma_f32 v[168:169], v[40:41], s[60:61], v[124:125] op_sel_hi:[1,0,0] neg_lo:[0,0,1] neg_hi:[0,0,1]
    v_exp_f32 v166, v166
    v_exp_f32 v167, v167
    v_pk_fma_f32 v[184:185], v[40:41], s[60:61], v[126:127] op_sel_hi:[1,0,0] neg_lo:[1,0,0] neg_hi:[1,0,0]
    v_exp_f32 v182, v182
    v_exp_f32 v183, v183
    v_pk_add_f32 v[112:113], v[112:113], v[138:139]
    v_pk_add_f32 v[114:115], v[114:115], v[154:155]
    s_waitcnt lgkmcnt(0)
    v_readfirstlane_b32 s101, v252
    s_cmp_lg_u32 s101, 7
    s_cbranch_scc1 M_Salpha
    s_mov_b64 exec, s[88:89]
    buffer_store_dword v255, v254, s[24:27], s93 offen sc1
    s_mov_b64 exec, -1
M_Salpha:
    v_pk_fma_f32 v[170:171], v[42:43], s[60:61], v[124:125] op_sel_hi:[1,0,0] neg_lo:[0,0,1] neg_hi:[0,0,1]
    v_exp_f32 v168, v168
    v_exp_f32 v169, v169
    v_pk_add_f32 v[120:121], v[160:161], v[162:163]
    v_pk_fma_f32 v[186:187], v[42:43], s[60:61], v[126:127] op_sel_hi:[1,0,0] neg_lo:[1,0,0] neg_hi:[1,0,0]
    v_exp_f32 v184, v184
    v_exp_f32 v185, v185
    v_pk_add_f32 v[122:123], v[176:177], v[178:179]
    v_pk_add_f32 v[112:113], v[112:113], v[140:141]
    v_pk_add_f32 v[114:115], v[114:115], v[156:157]
    v_pk_fma_f32 v[172:173], v[44:45], s[60:61], v[124:125] op_sel_hi:[1,0,0] neg_lo:[0,0,1] neg_hi:[0,0,1]
    v_exp_f32 v170, v170
    v_exp_f32 v171, v171
    v_pk_add_f32 v[120:121], v[120:121], v[164:165]
    v_pk_fma_f32 v[188:189], v[44:45], s[60:61], v[126:127] op_sel_hi:[1,0,0] neg_lo:[1,0,0] neg_hi:[1,0,0]
    v_exp_f32 v186, v186
    v_exp_f32 v187, v187
    v_pk_add_f32 v[122:123], v[122:123], v[180:181]
    v_pk_add_f32 v[112:113], v[112:113], v[142:143]
    v_pk_add_f32 v[114:115], v[114:115], v[158:159]
    v_pk_fma_f32 v[174:175], v[46:47], s[60:61], v[124:125] op_sel_hi:[1,0,0] neg_lo:[0,0,1] neg_hi:[0,0,1]
    v_exp_f32 v172, v172
    v_exp_f32 v173, v173
    v_pk_add_f32 v[120:121], v[120:121], v[166:167]
    v_pk_fma_f32 v[190:191], v[46:47], s[60:61], v[126:127] op_sel_hi:[1,0,0] neg_lo:[1,0,0] neg_hi:[1,0,0]
    v_exp_f32 v188, v188
    v_exp_f32 v189, v189
    v_pk_add_f32 v[122:123], v[122:123], v[182:183]
    v_add_f32 v112, v112, v113
    v_add_f32 v114, v114, v115
    v_exp_f32 v174, v174
    v_exp_f32 v175, v175
    v_pk_add_f32 v[120:121], v[120:121], v[168:169]
    v_exp_f32 v190, v190
    v_exp_f32 v191, v191
    v_pk_add_f32 v[122:123], v[122:123], v[184:185]
    v_mov_b32 v113, v112
    v_mov_b32 v115, v114
    v_pk_add_f32 v[120:121], v[120:121], v[170:171]
    v_pk_add_f32 v[122:123], v[122:123], v[186:187]
    v_pk_add_f32 v[120:121], v[120:121], v[172:173]
    v_pk_add_f32 v[122:123], v[122:123], v[188:189]
    v_pk_add_f32 v[120:121], v[120:121], v[174:175]
    v_pk_add_f32 v[122:123], v[122:123], v[190:191]
    v_permlane32_swap_b32 v112, v113
    v_permlane32_swap_b32 v114, v115
    v_add_f32 v120, v120, v121
    v_add_f32 v122, v122, v123
    v_add_f32 v112, v112, v113
    v_add_f32 v114, v114, v115
    v_mov_b32 v121, v120
    v_mov_b32 v123, v122
    v_rcp_f32 v112, v112
    v_rcp_f32 v114, v114
    v_permlane32_swap_b32 v120, v121
    v_permlane32_swap_b32 v122, v123
    v_pk_mul_f32 v[128:129], v[128:129], v[112:113] op_sel_hi:[1,0]
    v_pk_mul_f32 v[130:131], v[130:131], v[112:113] op_sel_hi:[1,0]
    v_pk_mul_f32 v[132:133], v[132:133], v[112:113] op_sel_hi:[1,0]
    v_pk_mul_f32 v[134:135], v[134:135], v[112:113] op_sel_hi:[1,0]
    v_pk_mul_f32 v[144:145], v[144:145], v[114:115] op_sel_hi:[1,0]
    v_pk_mul_f32 v[146:147], v[146:147], v[114:115] op_sel_hi:[1,0]
    v_pk_mul_f32 v[148:149], v[148:149], v[114:115] op_sel_hi:[1,0]
    v_pk_mul_f32 v[150:151], v[150:151], v[114:115] op_sel_hi:[1,0]
    v_add_f32 v120, v120, v121
    v_add_f32 v122, v122, v123
    v_cvt_pk_bf16_f32 v192, v128, v129
    v_cvt_pk_bf16_f32 v193, v130, v131
    v_cvt_pk_bf16_f32 v194, v132, v133
    v_cvt_pk_bf16_f32 v195, v134, v135
    v_cvt_pk_bf16_f32 v200, v144, v145
    v_cvt_pk_bf16_f32 v201, v146, v147
    v_cvt_pk_bf16_f32 v202, v148, v149
    v_cvt_pk_bf16_f32 v203, v150, v151
    v_rcp_f32 v120, v120
    v_rcp_f32 v122, v122
    v_pk_mul_f32 v[136:137], v[136:137], v[112:113] op_sel_hi:[1,0]
    v_pk_mul_f32 v[138:139], v[138:139], v[112:113] op_sel_hi:[1,0]
    v_pk_mul_f32 v[140:141], v[140:141], v[112:113] op_sel_hi:[1,0]
    v_pk_mul_f32 v[142:143], v[142:143], v[112:113] op_sel_hi:[1,0]
    v_pk_mul_f32 v[152:153], v[152:153], v[114:115] op_sel_hi:[1,0]
    v_pk_mul_f32 v[154:155], v[154:155], v[114:115] op_sel_hi:[1,0]
    v_pk_mul_f32 v[156:157], v[156:157], v[114:115] op_sel_hi:[1,0]
    v_pk_mul_f32 v[158:159], v[158:159], v[114:115] op_sel_hi:[1,0]
    v_cvt_pk_bf16_f32 v196, v136, v137
    v_cvt_pk_bf16_f32 v197, v138, v139
    v_cvt_pk_bf16_f32 v198, v140, v141
    v_cvt_pk_bf16_f32 v199, v142, v143
    v_cvt_pk_bf16_f32 v204, v152, v153
    v_cvt_pk_bf16_f32 v205, v154, v155
    v_cvt_pk_bf16_f32 v206, v156, v157
    v_cvt_pk_bf16_f32 v207, v158, v159
    v_pk_mul_f32 v[160:161], v[160:161], v[120:121] op_sel_hi:[1,0]
    v_pk_mul_f32 v[162:163], v[162:163], v[120:121] op_sel_hi:[1,0]
    v_pk_mul_f32 v[164:165], v[164:165], v[120:121] op_sel_hi:[1,0]
    v_pk_mul_f32 v[166:167], v[166:167], v[120:121] op_sel_hi:[1,0]
    v_pk_mul_f32 v[176:177], v[176:177], v[122:123] op_sel_hi:[1,0]
    v_pk_mul_f32 v[178:179], v[178:179], v[122:123] op_sel_hi:[1,0]
    v_pk_mul_f32 v[180:181], v[180:181], v[122:123] op_sel_hi:[1,0]
    v_pk_mul_f32 v[182:183], v[182:183], v[122:123] op_sel_hi:[1,0]
    v_mfma_f32_32x32x16_bf16 v[128:143], v[192:195], v[224:227], 0
    v_cvt_pk_bf16_f32 v208, v160, v161
    v_cvt_pk_bf16_f32 v209, v162, v163
    v_cvt_pk_bf16_f32 v210, v164, v165
    v_cvt_pk_bf16_f32 v211, v166, v167
    v_cvt_pk_bf16_f32 v216, v176, v177
    v_cvt_pk_bf16_f32 v217, v178, v179
    v_mfma_f32_32x32x16_bf16 v[144:159], v[200:203], v[224:227], 0
    v_cvt_pk_bf16_f32 v218, v180, v181
    v_cvt_pk_bf16_f32 v219, v182, v183
    v_pk_mul_f32 v[168:169], v[168:169], v[120:121] op_sel_hi:[1,0]
    v_pk_mul_f32 v[170:171], v[170:171], v[120:121] op_sel_hi:[1,0]
    v_pk_mul_f32 v[172:173], v[172:173], v[120:121] op_sel_hi:[1,0]
    v_pk_mul_f32 v[174:175], v[174:175], v[120:121] op_sel_hi:[1,0]
    v_pk_mul_f32 v[184:185], v[184:185], v[122:123] op_sel_hi:[1,0]
    v_pk_mul_f32 v[186:187], v[186:187], v[122:123] op_sel_hi:[1,0]
    v_pk_mul_f32 v[188:189], v[188:189], v[122:123] op_sel_hi:[1,0]
    v_pk_mul_f32 v[190:191], v[190:191], v[122:123] op_sel_hi:[1,0]
    v_mfma_f32_32x32x16_bf16 v[128:143], v[196:199], v[228:231], v[128:143]
    v_cvt_pk_bf16_f32 v212, v168, v169
    v_cvt_pk_bf16_f32 v213, v170, v171
    v_cvt_pk_bf16_f32 v214, v172, v173
    v_cvt_pk_bf16_f32 v215, v174, v175
    v_cvt_pk_bf16_f32 v220, v184, v185
    v_cvt_pk_bf16_f32 v221, v186, v187
    v_mfma_f32_32x32x16_bf16 v[144:159], v[204:207], v[228:231], v[144:159]
    v_cvt_pk_bf16_f32 v222, v188, v189
    v_cvt_pk_bf16_f32 v223, v190, v191
    v_cvt_pk_bf16_f32 v96, v96, v97
    v_permlane16_swap_b32 v80, v82
    v_permlane16_swap_b32 v81, v83
    v_cvt_pk_bf16_f32 v97, v98, v99
    v_mfma_f32_32x32x16_bf16 v[160:175], v[208:211], v[224:227], 0
    v_cvt_pk_bf16_f32 v98, v100, v101
    v_cvt_pk_bf16_f32 v99, v102, v103
    v_permlane16_swap_b32 v84, v86
    v_permlane16_swap_b32 v85, v87
    v_permlane32_swap_b32 v80, v82
    v_permlane32_swap_b32 v81, v83
    v_mfma_f32_32x32x16_bf16 v[176:191], v[216:219], v[224:227], 0
    v_cvt_pk_bf16_f32 v100, v104, v105
    v_cvt_pk_bf16_f32 v101, v106, v107
    v_cvt_pk_bf16_f32 v102, v108, v109
    v_cvt_pk_bf16_f32 v103, v110, v111
    v_cvt_pk_bf16_f32 v192, v128, v129
    v_cvt_pk_bf16_f32 v193, v130, v131
    v_mfma_f32_32x32x16_bf16 v[160:175], v[212:215], v[228:231], v[160:175]
    v_cvt_pk_bf16_f32 v194, v132, v133
    v_cvt_pk_bf16_f32 v195, v134, v135
    v_cvt_pk_bf16_f32 v200, v144, v145
    v_cvt_pk_bf16_f32 v201, v146, v147
    v_cvt_pk_bf16_f32 v202, v148, v149
    v_cvt_pk_bf16_f32 v203, v150, v151
    v_mfma_f32_32x32x16_bf16 v[176:191], v[220:223], v[228:231], v[176:191]
    v_permlane16_swap_b32 v96, v98
    v_permlane16_swap_b32 v97, v99
    v_permlane32_swap_b32 v84, v86
    v_permlane32_swap_b32 v85, v87
    v_cvt_pk_bf16_f32 v196, v136, v137
    v_cvt_pk_bf16_f32 v197, v138, v139
    v_cvt_pk_bf16_f32 v198, v140, v141
    v_cvt_pk_bf16_f32 v199, v142, v143
    v_cvt_pk_bf16_f32 v204, v152, v153
    v_cvt_pk_bf16_f32 v205, v154, v155
    v_cvt_pk_bf16_f32 v206, v156, v157
    v_cvt_pk_bf16_f32 v207, v158, v159
    v_permlane16_swap_b32 v100, v102
    v_permlane16_swap_b32 v101, v103
    v_mfma_f32_32x32x16_bf16 v[48:63], v[192:195], v[80:83], 0
    v_permlane32_swap_b32 v96, v98
    v_permlane32_swap_b32 v97, v99
    v_cvt_pk_bf16_f32 v208, v160, v161
    v_cvt_pk_bf16_f32 v209, v162, v163
    v_cvt_pk_bf16_f32 v210, v164, v165
    v_cvt_pk_bf16_f32 v211, v166, v167
    v_mfma_f32_16x16x32_bf16 v[244:247], v[232:235], v[192:195], 0
    v_cvt_pk_bf16_f32 v216, v176, v177
    v_cvt_pk_bf16_f32 v217, v178, v179
    v_mfma_f32_32x32x16_bf16 v[64:79], v[200:203], v[80:83], 0
    v_cvt_pk_bf16_f32 v218, v180, v181
    v_cvt_pk_bf16_f32 v219, v182, v183
    v_permlane32_swap_b32 v100, v102
    v_permlane32_swap_b32 v101, v103
    v_cvt_pk_bf16_f32 v212, v168, v169
    v_cvt_pk_bf16_f32 v213, v170, v171
    v_mfma_f32_16x16x32_bf16 v[248:251], v[232:235], v[200:203], 0
    v_cvt_pk_bf16_f32 v214, v172, v173
    v_cvt_pk_bf16_f32 v215, v174, v175
    v_mfma_f32_32x32x16_bf16 v[48:63], v[196:199], v[84:87], v[48:63]
    v_cvt_pk_bf16_f32 v220, v184, v185
    v_cvt_pk_bf16_f32 v221, v186, v187
    v_cvt_pk_bf16_f32 v222, v188, v189
    v_cvt_pk_bf16_f32 v223, v190, v191
    v_mfma_f32_16x16x32_bf16 v[244:247], v[232:235], v[196:199], v[244:247]
    v_mfma_f32_32x32x16_bf16 v[64:79], v[204:207], v[84:87], v[64:79]
    v_mfma_f32_16x16x32_bf16 v[248:251], v[232:235], v[204:207], v[248:251]
    v_mfma_f32_32x32x16_bf16 v[48:63], v[208:211], v[96:99], v[48:63]
    v_mfma_f32_16x16x32_bf16 v[244:247], v[232:235], v[208:211], v[244:247]
    v_mfma_f32_32x32x16_bf16 v[64:79], v[216:219], v[96:99], v[64:79]
    v_mfma_f32_16x16x32_bf16 v[248:251], v[232:235], v[216:219], v[248:251]
    v_mfma_f32_32x32x16_bf16 v[48:63], v[212:215], v[100:103], v[48:63]
    v_mfma_f32_16x16x32_bf16 v[244:247], v[232:235], v[212:215], v[244:247]
    v_mfma_f32_32x32x16_bf16 v[64:79], v[220:223], v[100:103], v[64:79]
    v_mfma_f32_16x16x32_bf16 v[248:251], v[232:235], v[220:223], v[248:251]
    s_lshl_b32 s56, s32, 13
    s_add_u32 s56, s56, 71680
    v_add_u32 v2, s56, v15
    s_lshl_b32 s56, s32, 8
    v_lshlrev_b32 v4, 2, v1
    v_add_u32 v5, s56, v4
    v_add_u32 v5, 137216, v5
    s_mov_b32 s58, 0
    s_mov_b32 s59, -1
    ds_write_b128 v2, v[48:51] offset:0
    ds_write_b128 v2, v[52:55] offset:1024
    ds_write_b128 v2, v[56:59] offset:2048
    ds_write_b128 v2, v[60:63] offset:3072
    ds_write_b128 v2, v[64:67] offset:4096
    ds_write_b128 v2, v[68:71] offset:5120
    ds_write_b128 v2, v[72:75] offset:6144
    ds_write_b128 v2, v[76:79] offset:7168
    v_cndmask_b32 v3, v244, v248, s[58:59]
    ds_write_b32 v5, v3
    s_lshl_b32 s58, s34, 11
    s_lshl_b32 s59, s3, 15
    s_add_u32 s58, s58, s59
    s_add_u32 s58, s58, 71680
    v_add_u32 v230, s58, v15
    s_lshl_b32 s58, s3, 10
    s_add_u32 s58, s58, 137216
    v_add_u32 v231, s58, v4
    s_lshl_b32 s58, s41, 3
    s_add_u32 s58, s58, s35
    s_lshl_b32 s59, s58, 13
    s_lshl_b32 s57, s34, 11
    s_add_u32 s59, s59, s57
    s_add_u32 s84, s59, 20971520
    s_lshl_b32 s58, s58, 8
    s_add_u32 s85, s58, 23068672
    s_branch K1_END2
K1_BETA:
    s_lshl_b32 s56, s42, 12
    s_add_u32 s57, s56, 4196352
    s_add_u32 s58, s57, 4096
    s_add_u32 s84, s56, 12582912
    s_add_u32 s85, s84, 4096
    s_lshl_b32 s56, s42, 11
    s_mov_b32 s62, 0x3e8293ee
    s_mov_b32 s63, 0x3e8293ee
    v_pk_mul_f32 v[48:49], v[48:49], s[62:63]
    v_pk_mul_f32 v[50:51], v[50:51], s[62:63]
    v_cvt_pk_bf16_f32 v48, v48, v49
    v_pk_mul_f32 v[52:53], v[52:53], s[62:63]
    v_pk_mul_f32 v[54:55], v[54:55], s[62:63]
    v_cvt_pk_bf16_f32 v49, v50, v51
    v_cvt_pk_bf16_f32 v50, v52, v53
    v_cvt_pk_bf16_f32 v51, v54, v55
    v_cvt_pk_bf16_f32 v80, v80, v81
    v_permlane16_swap_b32 v48, v50
    v_permlane16_swap_b32 v49, v51
    buffer_store_dwordx4 v[48:51], v15, s[24:27], s56 offen offset:0 sc1
    v_cvt_pk_bf16_f32 v81, v82, v83
    v_cvt_pk_bf16_f32 v82, v84, v85
    v_cvt_pk_bf16_f32 v83, v86, v87
    v_pk_mul_f32 v[56:57], v[56:57], s[62:63]
    v_permlane16_swap_b32 v80, v82
    v_permlane16_swap_b32 v81, v83
    v_pk_mul_f32 v[58:59], v[58:59], s[62:63]
    v_permlane32_swap_b32 v80, v82
    v_permlane32_swap_b32 v81, v83
    buffer_store_dwordx4 v[80:83], v15, s[24:27], s57 offen offset:0 sc1
    v_pk_mul_f32 v[60:61], v[60:61], s[62:63]
    v_pk_mul_f32 v[62:63], v[62:63], s[62:63]
    v_cvt_pk_bf16_f32 v52, v56, v57
    v_cvt_pk_bf16_f32 v53, v58, v59
    v_cvt_pk_bf16_f32 v54, v60, v61
    v_cvt_pk_bf16_f32 v55, v62, v63
    v_cvt_pk_bf16_f32 v84, v88, v89
    v_permlane16_swap_b32 v52, v54
    v_permlane16_swap_b32 v53, v55
    buffer_store_dwordx4 v[52:55], v15, s[24:27], s56 offen offset:1024 sc1
    v_cvt_pk_bf16_f32 v85, v90, v91
    v_cvt_pk_bf16_f32 v86, v92, v93
    v_cvt_pk_bf16_f32 v87, v94, v95
    v_pk_mul_f32 v[64:65], v[64:65], s[62:63]
    v_permlane16_swap_b32 v84, v86
    v_permlane16_swap_b32 v85, v87
    v_pk_mul_f32 v[66:67], v[66:67], s[62:63]
    v_permlane32_swap_b32 v84, v86
    v_permlane32_swap_b32 v85, v87
    buffer_store_dwordx4 v[84:87], v15, s[24:27], s57 offen offset:1024 sc1
    v_cvt_pk_bf16_f32 v64, v64, v65
    v_pk_mul_f32 v[68:69], v[68:69], s[62:63]
    v_pk_mul_f32 v[70:71], v[70:71], s[62:63]
    v_cvt_pk_bf16_f32 v65, v66, v67
    v_cvt_pk_bf16_f32 v66, v68, v69
    v_cvt_pk_bf16_f32 v67, v70, v71
    v_cvt_pk_bf16_f32 v96, v96, v97
    v_permlane16_swap_b32 v64, v66
    v_permlane16_swap_b32 v65, v67
    buffer_store_dwordx4 v[64:67], v15, s[24:27], s56 offen offset:2048 sc1
    v_cvt_pk_bf16_f32 v97, v98, v99
    v_cvt_pk_bf16_f32 v98, v100, v101
    v_cvt_pk_bf16_f32 v99, v102, v103
    v_cvt_pk_bf16_f32 v112, v16, v17
    v_permlane16_swap_b32 v96, v98
    v_permlane16_swap_b32 v97, v99
    v_cvt_pk_bf16_f32 v113, v18, v19
    v_permlane32_swap_b32 v96, v98
    v_permlane32_swap_b32 v97, v99
    buffer_store_dwordx4 v[96:99], v15, s[24:27], s58 offen offset:0 sc1
    v_cvt_pk_bf16_f32 v114, v20, v21
    v_cvt_pk_bf16_f32 v115, v22, v23
    v_cvt_pk_bf16_f32 v120, v32, v33
    v_cvt_pk_bf16_f32 v121, v34, v35
    v_cvt_pk_bf16_f32 v122, v36, v37
    v_cvt_pk_bf16_f32 v123, v38, v39
    v_cvt_pk_bf16_f32 v116, v24, v25
    v_cvt_pk_bf16_f32 v117, v26, v27
    v_cvt_pk_bf16_f32 v118, v28, v29
    v_cvt_pk_bf16_f32 v119, v30, v31
    v_cvt_pk_bf16_f32 v124, v40, v41
    v_cvt_pk_bf16_f32 v125, v42, v43
    v_cvt_pk_bf16_f32 v126, v44, v45
    v_cvt_pk_bf16_f32 v127, v46, v47
    v_permlane16_swap_b32 v112, v114
    v_permlane16_swap_b32 v113, v115
    v_permlane16_swap_b32 v120, v122
    v_permlane16_swap_b32 v121, v123
    v_permlane16_swap_b32 v116, v118
    v_permlane16_swap_b32 v117, v119
    v_permlane16_swap_b32 v124, v126
    v_permlane16_swap_b32 v125, v127
    v_mfma_f32_32x32x16_bf16 v[16:31], v[236:239], v[112:115], 0
    v_pk_mul_f32 v[72:73], v[72:73], s[62:63]
    v_pk_mul_f32 v[74:75], v[74:75], s[62:63]
    v_pk_mul_f32 v[76:77], v[76:77], s[62:63]
    v_pk_mul_f32 v[78:79], v[78:79], s[62:63]
    v_cvt_pk_bf16_f32 v68, v72, v73
    v_cvt_pk_bf16_f32 v69, v74, v75
    v_mfma_f32_32x32x16_bf16 v[32:47], v[236:239], v[120:123], 0
    v_cvt_pk_bf16_f32 v70, v76, v77
    v_cvt_pk_bf16_f32 v71, v78, v79
    v_cvt_pk_bf16_f32 v100, v104, v105
    v_permlane16_swap_b32 v68, v70
    v_permlane16_swap_b32 v69, v71
    buffer_store_dwordx4 v[68:71], v15, s[24:27], s56 offen offset:3072 sc1
    v_mfma_f32_32x32x16_bf16 v[16:31], v[240:243], v[116:119], v[16:31]
    v_cvt_pk_bf16_f32 v101, v106, v107
    v_cvt_pk_bf16_f32 v102, v108, v109
    v_cvt_pk_bf16_f32 v103, v110, v111
    s_nop 0
    v_permlane16_swap_b32 v100, v102
    v_permlane16_swap_b32 v101, v103
    v_mfma_f32_32x32x16_bf16 v[32:47], v[240:243], v[124:127], v[32:47]
    v_permlane32_swap_b32 v100, v102
    v_permlane32_swap_b32 v101, v103
    buffer_store_dwordx4 v[100:103], v15, s[24:27], s58 offen offset:1024 sc1
    s_nop 1
    v_cvt_pk_bf16_f32 v112, v16, v17
    v_cvt_pk_bf16_f32 v113, v18, v19
    v_cvt_pk_bf16_f32 v114, v20, v21
    v_cvt_pk_bf16_f32 v115, v22, v23
    v_cvt_pk_bf16_f32 v116, v24, v25
    v_cvt_pk_bf16_f32 v117, v26, v27
    v_cvt_pk_bf16_f32 v118, v28, v29
    v_cvt_pk_bf16_f32 v119, v30, v31
    v_cvt_pk_bf16_f32 v120, v32, v33
    v_cvt_pk_bf16_f32 v121, v34, v35
    v_cvt_pk_bf16_f32 v122, v36, v37
    v_cvt_pk_bf16_f32 v123, v38, v39
    v_cvt_pk_bf16_f32 v124, v40, v41
    v_cvt_pk_bf16_f32 v125, v42, v43
    v_cvt_pk_bf16_f32 v126, v44, v45
    v_cvt_pk_bf16_f32 v127, v46, v47
    v_mfma_f32_32x32x16_bf16 v[16:31], v[224:227], v[112:115], 0
    v_mfma_f32_32x32x16_bf16 v[32:47], v[224:227], v[120:123], 0
    v_mfma_f32_32x32x16_bf16 v[16:31], v[228:231], v[116:119], v[16:31]
    v_mfma_f32_32x32x16_bf16 v[32:47], v[228:231], v[124:127], v[32:47]
    s_nop 10
    v_max3_f32 v116, v16, v17, v18
    v_min3_f32 v118, v16, v17, v18
    v_max3_f32 v116, v116, v19, v20
    v_min3_f32 v118, v118, v19, v20
    v_max3_f32 v116, v116, v21, v22
    v_min3_f32 v118, v118, v21, v22
    v_max3_f32 v116, v116, v23, v24
    v_min3_f32 v118, v118, v23, v24
    v_max3_f32 v124, v32, v33, v34
    v_min3_f32 v126, v32, v33, v34
    v_max3_f32 v124, v124, v35, v36
    v_min3_f32 v126, v126, v35, v36
    v_max3_f32 v124, v124, v37, v38
    v_min3_f32 v126, v126, v37, v38
    v_max3_f32 v124, v124, v39, v40
    v_min3_f32 v126, v126, v39, v40
    v_max3_f32 v116, v116, v25, v26
    v_min3_f32 v118, v118, v25, v26
    v_max3_f32 v124, v124, v41, v42
    v_min3_f32 v126, v126, v41, v42
    v_max3_f32 v116, v116, v27, v28
    v_min3_f32 v118, v118, v27, v28
    v_max3_f32 v124, v124, v43, v44
    v_min3_f32 v126, v126, v43, v44
    v_max3_f32 v116, v116, v29, v30
    v_min3_f32 v118, v118, v29, v30
    v_max3_f32 v124, v124, v45, v46
    v_min3_f32 v126, v126, v45, v46
    v_max_f32 v116, v116, v31
    v_min_f32 v118, v118, v31
    v_max_f32 v124, v124, v47
    v_min_f32 v126, v126, v47
    v_mov_b32 v117, v116
    v_mov_b32 v119, v118
    v_mov_b32 v125, v124
    v_mov_b32 v127, v126
    v_permlane32_swap_b32 v116, v117
    v_permlane32_swap_b32 v118, v119
    v_permlane32_swap_b32 v124, v125
    v_permlane32_swap_b32 v126, v127
    v_max_f32 v116, v116, v117
    v_min_f32 v118, v118, v119
    v_max_f32 v124, v124, v125
    v_min_f32 v126, v126, v127
    v_mul_f32 v116, s60, v116
    v_mul_f32 v118, s60, v118
    v_mul_f32 v124, s60, v124
    v_mul_f32 v126, s60, v126
    v_pk_fma_f32 v[132:133], v[16:17], s[60:61], v[116:117] op_sel_hi:[1,0,0] neg_lo:[0,0,1] neg_hi:[0,0,1]
    v_pk_fma_f32 v[134:135], v[18:19], s[60:61], v[116:117] op_sel_hi:[1,0,0] neg_lo:[0,0,1] neg_hi:[0,0,1]
    v_pk_fma_f32 v[148:149], v[16:17], s[60:61], v[118:119] op_sel_hi:[1,0,0] neg_lo:[1,0,0] neg_hi:[1,0,0]
    v_pk_fma_f32 v[150:151], v[18:19], s[60:61], v[118:119] op_sel_hi:[1,0,0] neg_lo:[1,0,0] neg_hi:[1,0,0]
    v_pk_fma_f32 v[164:165], v[32:33], s[60:61], v[124:125] op_sel_hi:[1,0,0] neg_lo:[0,0,1] neg_hi:[0,0,1]
    v_pk_fma_f32 v[166:167], v[34:35], s[60:61], v[124:125] op_sel_hi:[1,0,0] neg_lo:[0,0,1] neg_hi:[0,0,1]
    v_pk_fma_f32 v[180:181], v[32:33], s[60:61], v[126:127] op_sel_hi:[1,0,0] neg_lo:[1,0,0] neg_hi:[1,0,0]
    v_pk_fma_f32 v[182:183], v[34:35], s[60:61], v[126:127] op_sel_hi:[1,0,0] neg_lo:[1,0,0] neg_hi:[1,0,0]
    v_pk_fma_f32 v[136:137], v[20:21], s[60:61], v[116:117] op_sel_hi:[1,0,0] neg_lo:[0,0,1] neg_hi:[0,0,1]
    v_exp_f32 v132, v132
    v_exp_f32 v133, v133
    v_exp_f32 v134, v134
    v_exp_f32 v135, v135
    v_pk_fma_f32 v[152:153], v[20:21], s[60:61], v[118:119] op_sel_hi:[1,0,0] neg_lo:[1,0,0] neg_hi:[1,0,0]
    v_exp_f32 v148, v148
    v_exp_f32 v149, v149
    v_exp_f32 v150, v150
    v_exp_f32 v151, v151
    v_pk_fma_f32 v[168:169], v[36:37], s[60:61], v[124:125] op_sel_hi:[1,0,0] neg_lo:[0,0,1] neg_hi:[0,0,1]
    v_exp_f32 v164, v164
    v_exp_f32 v165, v165
    v_exp_f32 v166, v166
    v_exp_f32 v167, v167
    v_pk_fma_f32 v[184:185], v[36:37], s[60:61], v[126:127] op_sel_hi:[1,0,0] neg_lo:[1,0,0] neg_hi:[1,0,0]
    s_waitcnt vmcnt(0)
    s_cmp_lg_u32 s32, 0
    s_cbranch_scc1 M_Ebeta
    v_cmp_ne_u32 vcc, 1, v252
    s_cbranch_vccnz M_LSPINbeta
M_LOKbeta:
M_Ebeta:
    s_mov_b64 exec, 1
    ds_add_rtn_u32 v252, v253, v255 offset:65472
    s_mov_b64 exec, -1
    s_mov_b32 s88, -1
    s_mov_b32 s89, 0xffff
    v_exp_f32 v180, v180
    v_exp_f32 v181, v181
    v_exp_f32 v182, v182
    v_exp_f32 v183, v183
    v_pk_fma_f32 v[138:139], v[22:23], s[60:61], v[116:117] op_sel_hi:[1,0,0] neg_lo:[0,0,1] neg_hi:[0,0,1]
    v_exp_f32 v136, v136
    v_exp_f32 v137, v137
    v_pk_fma_f32 v[154:155], v[22:23], s[60:61], v[118:119] op_sel_hi:[1,0,0] neg_lo:[1,0,0] neg_hi:[1,0,0]
    v_exp_f32 v152, v152
    v_exp_f32 v153, v153
    v_pk_fma_f32 v[170:171], v[38:39], s[60:61], v[124:125] op_sel_hi:[1,0,0] neg_lo:[0,0,1] neg_hi:[0,0,1]
    v_exp_f32 v168, v168
    v_exp_f32 v169, v169
    v_pk_fma_f32 v[186:187], v[38:39], s[60:61], v[126:127] op_sel_hi:[1,0,0] neg_lo:[1,0,0] neg_hi:[1,0,0]
    v_exp_f32 v184, v184
    v_exp_f32 v185, v185
    s_waitcnt lgkmcnt(0)
    v_readfirstlane_b32 s101, v252
    s_cmp_lg_u32 s101, 7
    s_cbranch_scc1 M_Sbeta
    s_mov_b64 exec, s[88:89]
    buffer_store_dword v255, v254, s[24:27], s93 offen sc1
    s_mov_b64 exec, -1
M_Sbeta:
    v_pk_fma_f32 v[140:141], v[24:25], s[60:61], v[116:117] op_sel_hi:[1,0,0] neg_lo:[0,0,1] neg_hi:[0,0,1]
    v_exp_f32 v138, v138
    v_exp_f32 v139, v139
    v_pk_fma_f32 v[156:157], v[24:25], s[60:61], v[118:119] op_sel_hi:[1,0,0] neg_lo:[1,0,0] neg_hi:[1,0,0]
    v_exp_f32 v154, v154
    v_exp_f32 v155, v155
    v_pk_fma_f32 v[172:173], v[40:41], s[60:61], v[124:125] op_sel_hi:[1,0,0] neg_lo:[0,0,1] neg_hi:[0,0,1]
    v_exp_f32 v170, v170
    v_exp_f32 v171, v171
    v_pk_fma_f32 v[188:189], v[40:41], s[60:61], v[126:127] op_sel_hi:[1,0,0] neg_lo:[1,0,0] neg_hi:[1,0,0]
    v_exp_f32 v186, v186
    v_exp_f32 v187, v187
    v_pk_fma_f32 v[142:143], v[26:27], s[60:61], v[116:117] op_sel_hi:[1,0,0] neg_lo:[0,0,1] neg_hi:[0,0,1]
    v_exp_f32 v140, v140
    v_exp_f32 v141, v141
    v_pk_add_f32 v[112:113], v[132:133], v[134:135]
    v_pk_fma_f32 v[158:159], v[26:27], s[60:61], v[118:119] op_sel_hi:[1,0,0] neg_lo:[1,0,0] neg_hi:[1,0,0]
    v_exp_f32 v156, v156
    v_exp_f32 v157, v157
    v_pk_add_f32 v[114:115], v[148:149], v[150:151]
    v_pk_fma_f32 v[174:175], v[42:43], s[60:61], v[124:125] op_sel_hi:[1,0,0] neg_lo:[0,0,1] neg_hi:[0,0,1]
    v_exp_f32 v172, v172
    v_exp_f32 v173, v173
    v_pk_add_f32 v[120:121], v[164:165], v[166:167]
    v_pk_fma_f32 v[190:191], v[42:43], s[60:61], v[126:127] op_sel_hi:[1,0,0] neg_lo:[1,0,0] neg_hi:[1,0,0]
    v_exp_f32 v188, v188
    v_exp_f32 v189, v189
    v_pk_add_f32 v[122:123], v[180:181], v[182:183]
    v_pk_fma_f32 v[144:145], v[28:29], s[60:61], v[116:117] op_sel_hi:[1,0,0] neg_lo:[0,0,1] neg_hi:[0,0,1]
    v_exp_f32 v142, v142
    v_exp_f32 v143, v143
    v_pk_add_f32 v[112:113], v[112:113], v[136:137]
    v_pk_fma_f32 v[160:161], v[28:29], s[60:61], v[118:119] op_sel_hi:[1,0,0] neg_lo:[1,0,0] neg_hi:[1,0,0]
    v_exp_f32 v158, v158
    v_exp_f32 v159, v159
    v_pk_add_f32 v[114:115], v[114:115], v[152:153]
    v_pk_fma_f32 v[176:177], v[44:45], s[60:61], v[124:125] op_sel_hi:[1,0,0] neg_lo:[0,0,1] neg_hi:[0,0,1]
    v_exp_f32 v174, v174
    v_exp_f32 v175, v175
    v_pk_add_f32 v[120:121], v[120:121], v[168:169]
    v_pk_fma_f32 v[192:193], v[44:45], s[60:61], v[126:127] op_sel_hi:[1,0,0] neg_lo:[1,0,0] neg_hi:[1,0,0]
    v_exp_f32 v190, v190
    v_exp_f32 v191, v191
    v_pk_add_f32 v[122:123], v[122:123], v[184:185]
    v_pk_fma_f32 v[146:147], v[30:31], s[60:61], v[116:117] op_sel_hi:[1,0,0] neg_lo:[0,0,1] neg_hi:[0,0,1]
    v_exp_f32 v144, v144
    v_exp_f32 v145, v145
    v_pk_add_f32 v[112:113], v[112:113], v[138:139]
    v_pk_fma_f32 v[162:163], v[30:31], s[60:61], v[118:119] op_sel_hi:[1,0,0] neg_lo:[1,0,0] neg_hi:[1,0,0]
    v_exp_f32 v160, v160
    v_exp_f32 v161, v161
    v_pk_add_f32 v[114:115], v[114:115], v[154:155]
    v_pk_fma_f32 v[178:179], v[46:47], s[60:61], v[124:125] op_sel_hi:[1,0,0] neg_lo:[0,0,1] neg_hi:[0,0,1]
    v_exp_f32 v176, v176
    v_exp_f32 v177, v177
    v_pk_add_f32 v[120:121], v[120:121], v[170:171]
    v_pk_fma_f32 v[194:195], v[46:47], s[60:61], v[126:127] op_sel_hi:[1,0,0] neg_lo:[1,0,0] neg_hi:[1,0,0]
    v_exp_f32 v192, v192
    v_exp_f32 v193, v193
    v_pk_add_f32 v[122:123], v[122:123], v[186:187]
    v_exp_f32 v146, v146
    v_exp_f32 v147, v147
    v_pk_add_f32 v[112:113], v[112:113], v[140:141]
    v_exp_f32 v162, v162
    v_exp_f32 v163, v163
    v_pk_add_f32 v[114:115], v[114:115], v[156:157]
    v_exp_f32 v178, v178
    v_exp_f32 v179, v179
    v_pk_add_f32 v[120:121], v[120:121], v[172:173]
    v_exp_f32 v194, v194
    v_exp_f32 v195, v195
    v_pk_add_f32 v[122:123], v[122:123], v[188:189]
    v_pk_add_f32 v[112:113], v[112:113], v[142:143]
    v_pk_add_f32 v[114:115], v[114:115], v[158:159]
    v_pk_add_f32 v[120:121], v[120:121], v[174:175]
    v_pk_add_f32 v[122:123], v[122:123], v[190:191]
    v_pk_add_f32 v[112:113], v[112:113], v[144:145]
    v_pk_add_f32 v[114:115], v[114:115], v[160:161]
    v_pk_add_f32 v[120:121], v[120:121], v[176:177]
    v_pk_add_f32 v[122:123], v[122:123], v[192:193]
    v_pk_add_f32 v[112:113], v[112:113], v[146:147]
    v_pk_add_f32 v[114:115], v[114:115], v[162:163]
    v_pk_add_f32 v[120:121], v[120:121], v[178:179]
    v_pk_add_f32 v[122:123], v[122:123], v[194:195]
    v_add_f32 v112, v112, v113
    v_add_f32 v114, v114, v115
    v_add_f32 v120, v120, v121
    v_add_f32 v122, v122, v123
    v_mov_b32 v113, v112
    v_mov_b32 v115, v114
    v_mov_b32 v121, v120
    v_mov_b32 v123, v122
    v_permlane32_swap_b32 v112, v113
    v_permlane32_swap_b32 v114, v115
    v_permlane32_swap_b32 v120, v121
    v_permlane32_swap_b32 v122, v123
    v_add_f32 v112, v112, v113
    v_add_f32 v114, v114, v115
    v_add_f32 v120, v120, v121
    v_add_f32 v122, v122, v123
    v_rcp_f32 v112, v112
    v_rcp_f32 v114, v114
    v_rcp_f32 v120, v120
    v_rcp_f32 v122, v122
    v_pk_mul_f32 v[132:133], v[132:133], v[112:113] op_sel_hi:[1,0]
    v_pk_mul_f32 v[148:149], v[148:149], v[114:115] op_sel_hi:[1,0]
    v_pk_mul_f32 v[164:165], v[164:165], v[120:121] op_sel_hi:[1,0]
    v_pk_mul_f32 v[180:181], v[180:181], v[122:123] op_sel_hi:[1,0]
    v_pk_mul_f32 v[134:135], v[134:135], v[112:113] op_sel_hi:[1,0]
    v_cvt_pk_bf16_f32 v132, v132, v133
    v_pk_mul_f32 v[150:151], v[150:151], v[114:115] op_sel_hi:[1,0]
    v_cvt_pk_bf16_f32 v148, v148, v149
    v_pk_mul_f32 v[166:167], v[166:167], v[120:121] op_sel_hi:[1,0]
    v_cvt_pk_bf16_f32 v164, v164, v165
    v_pk_mul_f32 v[182:183], v[182:183], v[122:123] op_sel_hi:[1,0]
    v_cvt_pk_bf16_f32 v180, v180, v181
    v_pk_mul_f32 v[136:137], v[136:137], v[112:113] op_sel_hi:[1,0]
    v_pk_mul_f32 v[138:139], v[138:139], v[112:113] op_sel_hi:[1,0]
    v_cvt_pk_bf16_f32 v133, v134, v135
    v_pk_mul_f32 v[152:153], v[152:153], v[114:115] op_sel_hi:[1,0]
    v_pk_mul_f32 v[154:155], v[154:155], v[114:115] op_sel_hi:[1,0]
    v_cvt_pk_bf16_f32 v149, v150, v151
    v_pk_mul_f32 v[168:169], v[168:169], v[120:121] op_sel_hi:[1,0]
    v_pk_mul_f32 v[170:171], v[170:171], v[120:121] op_sel_hi:[1,0]
    v_cvt_pk_bf16_f32 v165, v166, v167
    v_pk_mul_f32 v[184:185], v[184:185], v[122:123] op_sel_hi:[1,0]
    v_pk_mul_f32 v[186:187], v[186:187], v[122:123] op_sel_hi:[1,0]
    v_cvt_pk_bf16_f32 v181, v182, v183
    v_pk_mul_f32 v[140:141], v[140:141], v[112:113] op_sel_hi:[1,0]
    v_pk_mul_f32 v[142:143], v[142:143], v[112:113] op_sel_hi:[1,0]
    v_pk_mul_f32 v[144:145], v[144:145], v[112:113] op_sel_hi:[1,0]
    v_pk_mul_f32 v[146:147], v[146:147], v[112:113] op_sel_hi:[1,0]
    v_cvt_pk_bf16_f32 v134, v136, v137
    v_cvt_pk_bf16_f32 v135, v138, v139
    v_pk_mul_f32 v[156:157], v[156:157], v[114:115] op_sel_hi:[1,0]
    v_pk_mul_f32 v[158:159], v[158:159], v[114:115] op_sel_hi:[1,0]
    v_pk_mul_f32 v[160:161], v[160:161], v[114:115] op_sel_hi:[1,0]
    v_pk_mul_f32 v[162:163], v[162:163], v[114:115] op_sel_hi:[1,0]
    v_cvt_pk_bf16_f32 v150, v152, v153
    v_cvt_pk_bf16_f32 v151, v154, v155
    v_pk_mul_f32 v[172:173], v[172:173], v[120:121] op_sel_hi:[1,0]
    v_pk_mul_f32 v[174:175], v[174:175], v[120:121] op_sel_hi:[1,0]
    v_pk_mul_f32 v[176:177], v[176:177], v[120:121] op_sel_hi:[1,0]
    v_pk_mul_f32 v[178:179], v[178:179], v[120:121] op_sel_hi:[1,0]
    v_cvt_pk_bf16_f32 v166, v168, v169
    v_cvt_pk_bf16_f32 v167, v170, v171
    v_pk_mul_f32 v[188:189], v[188:189], v[122:123] op_sel_hi:[1,0]
    v_pk_mul_f32 v[190:191], v[190:191], v[122:123] op_sel_hi:[1,0]
    v_pk_mul_f32 v[192:193], v[192:193], v[122:123] op_sel_hi:[1,0]
    v_pk_mul_f32 v[194:195], v[194:195], v[122:123] op_sel_hi:[1,0]
    v_cvt_pk_bf16_f32 v182, v184, v185
    v_cvt_pk_bf16_f32 v183, v186, v187
    v_cvt_pk_bf16_f32 v136, v140, v141
    v_cvt_pk_bf16_f32 v137, v142, v143
    v_cvt_pk_bf16_f32 v138, v144, v145
    v_cvt_pk_bf16_f32 v139, v146, v147
    v_cvt_pk_bf16_f32 v152, v156, v157
    v_cvt_pk_bf16_f32 v153, v158, v159
    v_cvt_pk_bf16_f32 v154, v160, v161
    v_cvt_pk_bf16_f32 v155, v162, v163
    v_cvt_pk_bf16_f32 v168, v172, v173
    v_cvt_pk_bf16_f32 v169, v174, v175
    v_cvt_pk_bf16_f32 v170, v176, v177
    v_cvt_pk_bf16_f32 v171, v178, v179
    v_cvt_pk_bf16_f32 v184, v188, v189
    v_cvt_pk_bf16_f32 v185, v190, v191
    v_cvt_pk_bf16_f32 v186, v192, v193
    v_cvt_pk_bf16_f32 v187, v194, v195
K1_END2:
    s_mov_b64 s[4:5], s[52:53]
    s_load_dwordx2 s[56:57], s[0:1], 24
    s_load_dwordx2 s[58:59], s[0:1], 48
    s_load_dwordx2 s[50:51], s[0:1], 64
    s_and_b32 s3, s2, 7
    s_lshr_b32 s40, s2, 3
    s_and_b32 s41, s40, 3
    s_lshl_b32 s33, s3, 2
    s_add_u32 s33, s33, s41
    s_lshr_b32 s34, s40, 2
    v_lshrrev_b32 v2, 6, v0
    v_and_b32 v1, 63, v0
    v_readfirstlane_b32 s32, v2
    v_lshlrev_b32 v131, 4, v1
    s_lshl_b32 s39, s32, 11
    v_add_u32 v130, s39, v131
    s_lshl_b32 s36, s33, 18
    s_add_u32 s36, s36, 4194304
    s_mov_b32 s37, 0
    s_lshl_b32 s35, s34, 3
    s_add_u32 s35, s35, s32
    s_mov_b32 s8, s4
    s_mov_b32 s9, s5
    s_mov_b32 s10, 0x2000000
    s_mov_b32 s11, 0x20000
    v_and_b32 v2, 3, v1
    s_add_u32 s87, s34, 8
    v_mov_b32 v12, s87
    v_cmp_gt_u32 vcc, 2, v2
    v_lshlrev_b32 v2, 3, v2
    s_nop 0
    v_cndmask_b32 v12, v12, v2, vcc
    v_lshlrev_b32 v12, 2, v12
    v_lshlrev_b32 v232, 2, v1
    s_bitcmp1_b32 s2, 4
    s_cselect_b32 s87, 0, 0x40000000
    v_add_u32 v233, s87, v131
    s_cmp_lg_u32 s32, 0
    s_cbranch_scc1 M_NP
    buffer_load_dword v252, v12, s[8:11], s100 offen sc1
M_NP:
    s_lshl_b32 s40, s33, 6
    s_add_u32 s40, s40, s35
    s_lshl_b32 s86, s40, 11
    s_lshl_b32 s22, s40, 12
    s_add_u32 s22, s22, 12582912
    s_lshl_b32 s20, s33, 16
    s_lshl_b32 s42, s32, 10
    s_add_u32 s20, s20, s42
    s_add_u32 s20, s20, 20971520
    s_lshl_b32 s21, s33, 11
    s_add_u32 s21, s21, 23068672
    v_lshlrev_b32 v208, 2, v1
    v_and_b32 v213, 124, v208
    s_lshl_b32 s25, s35, 7
    s_add_u32 s25, s25, 23592960
    s_lshl_b32 s40, s35, 17
    s_lshl_b32 s41, s33, 11
    s_add_u32 s40, s40, s41
    s_add_u32 s23, s40, 25165824
    s_add_u32 s24, s23, 65536
    s_lshr_b32 s41, s32, 1
    s_lshl_b32 s41, s41, 10
    s_and_b32 s42, s32, 1
    s_lshl_b32 s42, s42, 3
    s_add_u32 s41, s41, s42
    s_add_u32 s41, s41, 65536
    v_add_u32 v209, s41, v131
    v_add_u32 v212, 65536, v131
    s_lshl_b32 s41, s32, 7
    s_add_u32 s41, s41, 69632
    v_lshl_add_u32 v210, v1, 1, s41
    v_lshrrev_b32 v4, 5, v1
    v_lshl_add_u32 v4, v4, 3, s41
    v_add_u32 v5, 70656, v208
    v_mov_b32 v3, 0
    ds_write_b32 v5, v3
    s_waitcnt lgkmcnt(0)
    s_cmp_lt_u32 s2, 128
    s_cselect_b32 s60, s56, s58
    s_cselect_b32 s61, s57, s59
    s_mov_b32 s52, s60
    s_mov_b32 s53, s61
    s_mov_b32 s54, 0x200000
    s_mov_b32 s55, 0x20000
    s_bfe_u32 s60, s2, 0x40003
    s_lshl_b32 s60, s60, 3
    s_add_u32 s60, s60, s32
    s_lshl_b32 s60, s60, 14
    s_and_b32 s61, s2, 1
    s_xor_b32 s61, s61, 0
    s_lshl_b32 s61, s61, 10
    s_add_u32 s60, s60, s61
    v_and_b32 v7, 7, v1
    v_lshlrev_b32 v6, 7, v7
    s_mov_b32 s26, 0
    v_add_u32 v11, s60, v6
    v_and_b32 v6, 3, v1
    v_bfe_u32 v7, v1, 2, 1
    v_bfe_u32 v8, v1, 4, 1
    v_xor_b32 v7, v7, v8
    s_cmp_lg_u32 s32, 0
    s_cbranch_scc1 M_EOK
    s_waitcnt vmcnt(0)
    v_cmp_ne_u32 vcc, 1, v252
    s_cbranch_vccnz M_ESPIN
M_EOK:
    s_waitcnt lgkmcnt(0)
    s_barrier
    buffer_load_dwordx4 v[16:19], v131, s[8:11], s86 offen offset:0 sc1
    buffer_load_dwordx4 v[20:23], v131, s[8:11], s86 offen offset:1024 sc1
    s_add_u32 m0, s37, s39
    s_add_u32 s37, s37, 16384
    buffer_load_dwordx4 v130, s[8:11], s36 offen sc1 lds
    buffer_load_dwordx4 v130, s[8:11], s36 offen offset:1024 sc1 lds
    s_and_b32 s37, s37, 65535
    s_add_u32 s36, s36, 16384
    s_add_u32 m0, s37, s39
    s_add_u32 s37, s37, 16384
    buffer_load_dwordx4 v130, s[8:11], s36 offen sc1 lds
    buffer_load_dwordx4 v130, s[8:11], s36 offen offset:1024 sc1 lds
    s_and_b32 s37, s37, 65535
    s_add_u32 s36, s36, 16384
    s_bitcmp1_b32 s2, 4
    s_cbranch_scc1 M_RB
    ds_read_b128 v[148:151], v230 offset:0
    ds_read_b128 v[156:159], v230 offset:8192
    ds_read_b128 v[164:167], v230 offset:16384
    ds_read_b128 v[172:175], v230 offset:24576
    ds_read_b128 v[152:155], v230 offset:1024
    ds_read_b128 v[160:163], v230 offset:9216
    ds_read_b128 v[168:171], v230 offset:17408
    ds_read_b128 v[176:179], v230 offset:25600
    ds_read_b32 v180, v231 offset:0
    ds_read_b32 v181, v231 offset:256
    ds_read_b32 v182, v231 offset:512
    ds_read_b32 v183, v231 offset:768
    s_waitcnt lgkmcnt(8)
    v_pk_add_f32 v[148:149], v[148:149], v[156:157]
    v_pk_add_f32 v[164:165], v[164:165], v[172:173]
    v_pk_add_f32 v[148:149], v[148:149], v[164:165]
    v_pk_add_f32 v[150:151], v[150:151], v[158:159]
    v_pk_add_f32 v[166:167], v[166:167], v[174:175]
    v_pk_add_f32 v[150:151], v[150:151], v[166:167]
    buffer_store_dwordx4 v[148:151], v131, s[8:11], s84 offen offset:0 sc1
    s_waitcnt lgkmcnt(4)
    v_pk_add_f32 v[152:153], v[152:153], v[160:161]
    v_pk_add_f32 v[168:169], v[168:169], v[176:177]
    v_pk_add_f32 v[152:153], v[152:153], v[168:169]
    v_pk_add_f32 v[154:155], v[154:155], v[162:163]
    v_pk_add_f32 v[170:171], v[170:171], v[178:179]
    v_pk_add_f32 v[154:155], v[154:155], v[170:171]
    buffer_store_dwordx4 v[152:155], v131, s[8:11], s84 offen offset:1024 sc1
    s_waitcnt lgkmcnt(0)
    v_add_f32 v180, v180, v181
    v_add_f32 v182, v182, v183
    v_add_f32 v180, v180, v182
    buffer_store_dword v180, v232, s[8:11], s85 offen sc1
M_RB:
    v_or_b32 v6, v6, v7
    v_mov_b32 v8, 0x3f803f80
    v_cmp_eq_u32 vcc, 0, v6
    v_mov_b32 v5, 70656
    s_nop 0
    v_cndmask_b32 v211, v5, v4, vcc
    v_and_b32 v6, 6, v1
    v_cmp_eq_u32 vcc, 0, v6
    s_nop 1
    v_cndmask_b32 v124, 0, v8, vcc
    v_cndmask_b32 v125, 0, v8, vcc
    v_cmp_eq_u32 vcc, 4, v6
    s_nop 1
    v_cndmask_b32 v126, 0, v8, vcc
    v_cndmask_b32 v127, 0, v8, vcc
    v_and_b32 v6, 1, v1
    v_cmp_eq_u32 vcc, 0, v6
    v_mov_b32 v6, 0x44444444
    v_mov_b32 v7, 0xeeeeeeee
    v_cndmask_b32 v215, v7, v6, vcc
    s_and_b32 s3, s2, 7
    s_lshr_b32 s31, s2, 3
    s_lshr_b32 s27, s3, 1
    s_lshl_b32 s27, s27, 2
    s_and_b32 s43, s31, 3
    s_add_u32 s27, s27, s43
    s_and_b32 s30, s3, 1
    s_lshl_b32 s30, s30, 3
    s_lshr_b32 s43, s31, 2
    s_add_u32 s30, s30, s43
    s_and_b32 s44, s32, 3
    s_lshr_b32 s45, s32, 2
    s_mov_b32 s12, s56
    s_mov_b32 s13, s57
    s_mov_b32 s14, 0x200000
    s_mov_b32 s15, 0x20000
    s_mov_b32 s16, s50
    s_mov_b32 s17, s51
    s_mov_b32 s18, 0x400000
    s_mov_b32 s19, 0x20000
    v_lshrrev_b32 v3, 3, v1
    v_and_b32 v4, 7, v1
    v_bfe_u32 v5, v1, 4, 1
    v_lshlrev_b32 v5, 2, v5
    v_xor_b32 v4, v4, v5
    s_lshl_b32 s31, s44, 4
    v_add_u32 v3, s31, v3
    v_lshlrev_b32 v3, 11, v3
    v_lshl_add_u32 v3, v4, 4, v3
    s_lshl_b32 s43, s30, 7
    s_lshl_b32 s31, s45, 20
    s_add_u32 s43, s43, s31
    v_add_u32 v216, s43, v3
    v_add_u32 v217, 0x4000, v216
    s_lshl_b32 s28, s45, 13
    s_lshl_b32 s31, s44, 11
    s_add_u32 s28, s28, s31
    s_add_u32 s28, s28, 71680
    s_lshl_b32 s31, s34, 5
    v_and_b32 v3, 31, v1
    v_add_u32 v3, s31, v3
    v_lshlrev_b32 v3, 9, v3
    s_lshl_b32 s31, s33, 2
    v_add_u32 v218, s31, v3
    v_and_b32 v3, 31, v1
    v_lshlrev_b32 v219, 2, v3
    v_mov_b32 v221, 1
    s_lshl_b32 s31, s27, 2
    s_add_u32 s31, s31, s44
    s_lshl_b32 s31, s31, 17
    s_lshl_b32 s43, s45, 15
    s_add_u32 s31, s31, s43
    s_add_u32 s45, s31, 25165824
    s_lshl_b32 s60, s27, 4
    s_add_u32 s60, s60, s30
    s_lshl_b32 s60, s60, 9
    s_add_u32 s60, s60, 24117248
    s_cmp_eq_u32 s32, 0
    s_cselect_b32 s61, 0, 0x40000000
    v_add_u32 v222, s61, v219
    s_cselect_b32 s61, 1, 0
    s_cmp_eq_u32 s32, 0
    s_cselect_b32 s87, 16, 0
    v_add_u32 v224, 192, v254
    v_mov_b32 v3, 0x40000000
    v_cmp_gt_u32 vcc, s87, v1
    s_nop 1
    v_cndmask_b32 v224, v3, v224, vcc
    v_min_u32 v226, 47, v1
    v_add_u32 v226, 16, v226
    v_lshlrev_b32 v226, 2, v226
    v_mov_b32 v128, v131
    v_add_u32 v129, 16384, v131
    v_mov_b32 v88, 0
    v_mov_b32 v89, 0
    v_mov_b32 v90, 0
    v_mov_b32 v91, 0
    v_mov_b32 v92, 0
    v_mov_b32 v93, 0
    v_mov_b32 v94, 0
    v_mov_b32 v95, 0
    v_mov_b32 v96, 0
    v_mov_b32 v97, 0
    v_mov_b32 v98, 0
    v_mov_b32 v99, 0
    v_mov_b32 v100, 0
    v_mov_b32 v101, 0
    v_mov_b32 v102, 0
    v_mov_b32 v103, 0
    v_mov_b32 v104, 0
    v_mov_b32 v105, 0
    v_mov_b32 v106, 0
    v_mov_b32 v107, 0
    s_bitcmp1_b32 s2, 4
    s_cbranch_scc1 M_WB
    s_waitcnt vmcnt(5)
    s_branch M_WJ
M_WB:
    s_waitcnt vmcnt(2)
M_WJ:
    s_waitcnt lgkmcnt(0)
    s_barrier
    buffer_load_dword v229, v253, s[8:11], s100 offen sc1
    ds_read_b128 v[24:27], v128
    ds_read_b128 v[28:31], v128 offset:1024
    ds_read_b128 v[32:35], v128 offset:4096
    ds_read_b128 v[36:39], v128 offset:5120
    s_waitcnt lgkmcnt(2)
    v_mfma_f32_32x32x16_bf16 v[40:55], v[24:27], v[16:19], 0
    v_mfma_f32_32x32x16_bf16 v[40:55], v[28:31], v[20:23], v[40:55]
    s_nop 11
    v_max3_f32 v2, v40, v41, v42
    v_max3_f32 v3, v44, v45, v46
    v_max3_f32 v4, v48, v49, v50
    v_max3_f32 v5, v52, v53, v54
    v_max3_f32 v2, v2, v43, v47
    v_max3_f32 v4, v4, v51, v55
    v_max3_f32 v2, v2, v3, v5
    v_max_f32 v2, v2, v4
    v_mov_b32 v3, v2
    s_nop 1
    v_permlane32_swap_b32 v2, v3
    v_max_f32 v2, v2, v3
    v_sub_f32 v2, 0xc2b40000, v2
    v_mov_b32 v108, v2
    v_mov_b32 v109, v2
    v_mov_b32 v110, v2
    v_mov_b32 v111, v2
    v_mov_b32 v112, v2
    v_mov_b32 v113, v2
    v_mov_b32 v114, v2
    v_mov_b32 v115, v2
    v_mov_b32 v116, v2
    v_mov_b32 v117, v2
    v_mov_b32 v118, v2
    v_mov_b32 v119, v2
    v_mov_b32 v120, v2
    v_mov_b32 v121, v2
    v_mov_b32 v122, v2
    v_mov_b32 v123, v2
    s_nop 1
    v_mfma_f32_32x32x16_bf16 v[40:55], v[24:27], v[16:19], v[108:123]
    v_mfma_f32_32x32x16_bf16 v[40:55], v[28:31], v[20:23], v[40:55]
    s_waitcnt lgkmcnt(0)
    v_mfma_f32_32x32x16_bf16 v[56:71], v[32:35], v[16:19], v[108:123]
    s_nop 9
    v_exp_f32 v40, v40
    v_exp_f32 v41, v41
    v_exp_f32 v42, v42
    v_exp_f32 v43, v43
    v_mfma_f32_32x32x16_bf16 v[56:71], v[36:39], v[20:23], v[56:71]
    ds_read_b128 v[24:27], v128 offset:8192
    ds_read_b128 v[28:31], v128 offset:9216
    v_cvt_pk_bf16_f32 v72, v40, v41
    v_exp_f32 v44, v44
    v_exp_f32 v45, v45
    v_cvt_pk_bf16_f32 v73, v42, v43
    v_exp_f32 v46, v46
    v_exp_f32 v47, v47
    v_cvt_pk_bf16_f32 v74, v44, v45
    v_exp_f32 v48, v48
    v_exp_f32 v49, v49
    v_cvt_pk_bf16_f32 v75, v46, v47
    v_exp_f32 v50, v50
    v_exp_f32 v51, v51
    ds_read_b128 v[32:35], v128 offset:2048
    ds_read_b128 v[36:39], v128 offset:3072
    v_cvt_pk_bf16_f32 v76, v48, v49
    v_exp_f32 v52, v52
    v_exp_f32 v53, v53
    v_cvt_pk_bf16_f32 v77, v50, v51
    v_exp_f32 v54, v54
    v_exp_f32 v55, v55
    v_cvt_pk_bf16_f32 v78, v52, v53
    v_cvt_pk_bf16_f32 v79, v54, v55
    s_waitcnt lgkmcnt(2)
    v_mfma_f32_32x32x16_bf16 v[40:55], v[24:27], v[16:19], v[108:123]
    v_exp_f32 v56, v56
    v_exp_f32 v57, v57
    v_exp_f32 v58, v58
    v_exp_f32 v59, v59
    v_mfma_f32_32x32x16_bf16 v[40:55], v[28:31], v[20:23], v[40:55]
    ds_read_b128 v[24:27], v128 offset:12288
    ds_read_b128 v[28:31], v128 offset:13312
    v_cvt_pk_bf16_f32 v80, v56, v57
    v_exp_f32 v60, v60
    v_exp_f32 v61, v61
    v_cvt_pk_bf16_f32 v81, v58, v59
    s_waitcnt lgkmcnt(2)
    v_mfma_f32_32x32x16_bf16 v[88:103], v[32:35], v[72:75], v[88:103]
    v_exp_f32 v62, v62
    v_exp_f32 v63, v63
    v_cvt_pk_bf16_f32 v82, v60, v61
    v_exp_f32 v64, v64
    v_exp_f32 v65, v65
    v_cvt_pk_bf16_f32 v83, v62, v63
    v_exp_f32 v66, v66
    v_exp_f32 v67, v67
    v_mfma_f32_32x32x16_bf16 v[88:103], v[36:39], v[76:79], v[88:103]
    ds_read_b128 v[32:35], v128 offset:6144
    ds_read_b128 v[36:39], v128 offset:7168
    v_cvt_pk_bf16_f32 v84, v64, v65
    v_exp_f32 v68, v68
    v_exp_f32 v69, v69
    v_cvt_pk_bf16_f32 v85, v66, v67
    v_smfmac_f32_16x16x64_bf16 v[104:107], v[124:127], v[72:79], v215
    v_exp_f32 v70, v70
    v_exp_f32 v71, v71
    v_cvt_pk_bf16_f32 v86, v68, v69
    v_cvt_pk_bf16_f32 v87, v70, v71
    s_waitcnt vmcnt(1)
    s_waitcnt vmcnt(0)
    v_cmp_ne_u32 vcc, 1, v229
    s_cbranch_vccnz M_FSPIN
M_FOK:
    s_barrier
    s_add_u32 m0, s37, s39
    s_add_u32 s37, s37, 16384
    buffer_load_dwordx4 v130, s[8:11], s36 offen sc1 lds
    buffer_load_dwordx4 v130, s[8:11], s36 offen offset:1024 sc1 lds
    s_and_b32 s37, s37, 65535
    s_add_u32 s36, s36, 16384
    s_waitcnt lgkmcnt(2)
    v_mfma_f32_32x32x16_bf16 v[56:71], v[24:27], v[16:19], v[108:123]
    v_exp_f32 v40, v40
    v_exp_f32 v41, v41
    v_exp_f32 v42, v42
    v_exp_f32 v43, v43
    v_mfma_f32_32x32x16_bf16 v[56:71], v[28:31], v[20:23], v[56:71]
    ds_read_b128 v[24:27], v129 offset:0
    ds_read_b128 v[28:31], v129 offset:1024
    v_cvt_pk_bf16_f32 v72, v40, v41
    v_exp_f32 v44, v44
    v_exp_f32 v45, v45
    v_cvt_pk_bf16_f32 v73, v42, v43
    s_waitcnt lgkmcnt(2)
    v_mfma_f32_32x32x16_bf16 v[88:103], v[32:35], v[80:83], v[88:103]
    v_exp_f32 v46, v46
    v_exp_f32 v47, v47
    v_cvt_pk_bf16_f32 v74, v44, v45
    v_exp_f32 v48, v48
    s_add_u32 m0, s37, s39
    s_add_u32 s37, s37, 16384
    buffer_load_dwordx4 v130, s[8:11], s36 offen sc1 lds
    v_exp_f32 v49, v49
    v_cvt_pk_bf16_f32 v75, v46, v47
    v_exp_f32 v50, v50
    v_exp_f32 v51, v51
    v_mfma_f32_32x32x16_bf16 v[88:103], v[36:39], v[84:87], v[88:103]
    ds_read_b128 v[32:35], v128 offset:10240
    ds_read_b128 v[36:39], v128 offset:11264
    v_cvt_pk_bf16_f32 v76, v48, v49
    v_exp_f32 v52, v52
    v_exp_f32 v53, v53
    v_cvt_pk_bf16_f32 v77, v50, v51
    v_smfmac_f32_16x16x64_bf16 v[104:107], v[124:127], v[80:87], v215
    v_exp_f32 v54, v54
    v_exp_f32 v55, v55
    v_cvt_pk_bf16_f32 v78, v52, v53
    v_cvt_pk_bf16_f32 v79, v54, v55
    s_waitcnt lgkmcnt(2)
    v_mfma_f32_32x32x16_bf16 v[40:55], v[24:27], v[16:19], v[108:123]
    v_exp_f32 v56, v56
    v_exp_f32 v57, v57
    v_exp_f32 v58, v58
    v_exp_f32 v59, v59
    v_mfma_f32_32x32x16_bf16 v[40:55], v[28:31], v[20:23], v[40:55]
    ds_read_b128 v[24:27], v129 offset:4096
    ds_read_b128 v[28:31], v129 offset:5120
    v_cvt_pk_bf16_f32 v80, v56, v57
    v_exp_f32 v60, v60
    v_exp_f32 v61, v61
    v_cvt_pk_bf16_f32 v81, v58, v59
    s_waitcnt lgkmcnt(2)
    v_mfma_f32_32x32x16_bf16 v[88:103], v[32:35], v[72:75], v[88:103]
    v_exp_f32 v62, v62
    v_exp_f32 v63, v63
    v_cvt_pk_bf16_f32 v82, v60, v61
    v_exp_f32 v64, v64
    buffer_load_dwordx4 v130, s[8:11], s36 offen offset:1024 sc1 lds
    s_and_b32 s37, s37, 65535
    s_add_u32 s36, s36, 16384
    v_exp_f32 v65, v65
    v_cvt_pk_bf16_f32 v83, v62, v63
    v_exp_f32 v66, v66
    v_exp_f32 v67, v67
    v_mfma_f32_32x32x16_bf16 v[88:103], v[36:39], v[76:79], v[88:103]
    ds_read_b128 v[32:35], v128 offset:14336
    ds_read_b128 v[36:39], v128 offset:15360
    v_cvt_pk_bf16_f32 v84, v64, v65
    v_exp_f32 v68, v68
    v_exp_f32 v69, v69
    v_cvt_pk_bf16_f32 v85, v66, v67
    v_smfmac_f32_16x16x64_bf16 v[104:107], v[124:127], v[72:79], v215
    v_exp_f32 v70, v70
    v_exp_f32 v71, v71
    v_cvt_pk_bf16_f32 v86, v68, v69
    v_cvt_pk_bf16_f32 v87, v70, v71
    v_mov_b32 v128, v129
    v_add_u32 v129, 16384, v129
    v_and_b32 v129, 65535, v129
    s_waitcnt lgkmcnt(2)
    v_mfma_f32_32x32x16_bf16 v[56:71], v[24:27], v[16:19], v[108:123]
    v_exp_f32 v40, v40
    v_exp_f32 v41, v41
    v_exp_f32 v42, v42
    v_exp_f32 v43, v43
    v_mfma_f32_32x32x16_bf16 v[56:71], v[28:31], v[20:23], v[56:71]
    ds_read_b128 v[24:27], v128 offset:8192
    ds_read_b128 v[28:31], v128 offset:9216
    v_cvt_pk_bf16_f32 v72, v40, v41
    v_exp_f32 v44, v44
    v_exp_f32 v45, v45
    v_cvt_pk_bf16_f32 v73, v42, v43
    s_waitcnt lgkmcnt(2)
    v_mfma_f32_32x32x16_bf16 v[88:103], v[32:35], v[80:83], v[88:103]
    v_exp_f32 v46, v46
    v_exp_f32 v47, v47
    v_cvt_pk_bf16_f32 v74, v44, v45
    v_exp_f32 v48, v48
    buffer_store_dwordx4 v[132:135], v233, s[8:11], s84 offen offset:0 sc1
    v_exp_f32 v49, v49
    v_cvt_pk_bf16_f32 v75, v46, v47
    v_exp_f32 v50, v50
    v_exp_f32 v51, v51
    v_mfma_f32_32x32x16_bf16 v[88:103], v[36:39], v[84:87], v[88:103]
    ds_read_b128 v[32:35], v128 offset:2048
    ds_read_b128 v[36:39], v128 offset:3072
    v_cvt_pk_bf16_f32 v76, v48, v49
    v_exp_f32 v52, v52
    v_exp_f32 v53, v53
    v_cvt_pk_bf16_f32 v77, v50, v51
    v_smfmac_f32_16x16x64_bf16 v[104:107], v[124:127], v[80:87], v215
    v_exp_f32 v54, v54
    v_exp_f32 v55, v55
    v_cvt_pk_bf16_f32 v78, v52, v53
    v_cvt_pk_bf16_f32 v79, v54, v55
    s_waitcnt lgkmcnt(2)
    v_mfma_f32_32x32x16_bf16 v[40:55], v[24:27], v[16:19], v[108:123]
    v_exp_f32 v56, v56
    v_exp_f32 v57, v57
    v_exp_f32 v58, v58
    v_exp_f32 v59, v59
    v_mfma_f32_32x32x16_bf16 v[40:55], v[28:31], v[20:23], v[40:55]
    ds_read_b128 v[24:27], v128 offset:12288
    ds_read_b128 v[28:31], v128 offset:13312
    v_cvt_pk_bf16_f32 v80, v56, v57
    v_exp_f32 v60, v60
    v_exp_f32 v61, v61
    v_cvt_pk_bf16_f32 v81, v58, v59
    s_waitcnt lgkmcnt(2)
    v_mfma_f32_32x32x16_bf16 v[88:103], v[32:35], v[72:75], v[88:103]
    v_exp_f32 v62, v62
    v_exp_f32 v63, v63
    v_cvt_pk_bf16_f32 v82, v60, v61
    v_exp_f32 v64, v64
    buffer_store_dwordx4 v[136:139], v233, s[8:11], s84 offen offset:1024 sc1
    v_exp_f32 v65, v65
    v_cvt_pk_bf16_f32 v83, v62, v63
    v_exp_f32 v66, v66
    v_exp_f32 v67, v67
    v_mfma_f32_32x32x16_bf16 v[88:103], v[36:39], v[76:79], v[88:103]
    ds_read_b128 v[32:35], v128 offset:6144
    ds_read_b128 v[36:39], v128 offset:7168
    v_cvt_pk_bf16_f32 v84, v64, v65
    v_exp_f32 v68, v68
    v_exp_f32 v69, v69
    v_cvt_pk_bf16_f32 v85, v66, v67
    v_smfmac_f32_16x16x64_bf16 v[104:107], v[124:127], v[72:79], v215
    v_exp_f32 v70, v70
    v_exp_f32 v71, v71
    v_cvt_pk_bf16_f32 v86, v68, v69
    v_cvt_pk_bf16_f32 v87, v70, v71
    s_waitcnt vmcnt(4)
    s_barrier
    s_waitcnt lgkmcnt(2)
    v_mfma_f32_32x32x16_bf16 v[56:71], v[24:27], v[16:19], v[108:123]
    v_exp_f32 v40, v40
    v_exp_f32 v41, v41
    v_exp_f32 v42, v42
    v_exp_f32 v43, v43
    v_mfma_f32_32x32x16_bf16 v[56:71], v[28:31], v[20:23], v[56:71]
    ds_read_b128 v[24:27], v129 offset:0
    ds_read_b128 v[28:31], v129 offset:1024
    v_cvt_pk_bf16_f32 v72, v40, v41
    v_exp_f32 v44, v44
    v_exp_f32 v45, v45
    v_cvt_pk_bf16_f32 v73, v42, v43
    s_waitcnt lgkmcnt(2)
    v_mfma_f32_32x32x16_bf16 v[88:103], v[32:35], v[80:83], v[88:103]
    v_exp_f32 v46, v46
    v_exp_f32 v47, v47
    v_cvt_pk_bf16_f32 v74, v44, v45
    v_exp_f32 v48, v48
    s_add_u32 m0, s37, s39
    s_add_u32 s37, s37, 16384
    buffer_load_dwordx4 v130, s[8:11], s36 offen sc1 lds
    buffer_store_dwordx4 v[148:151], v233, s[8:11], s84 offen offset:2048 sc1
    v_exp_f32 v49, v49
    v_cvt_pk_bf16_f32 v75, v46, v47
    v_exp_f32 v50, v50
    v_exp_f32 v51, v51
    v_mfma_f32_32x32x16_bf16 v[88:103], v[36:39], v[84:87], v[88:103]
    ds_read_b128 v[32:35], v128 offset:10240
    ds_read_b128 v[36:39], v128 offset:11264
    v_cvt_pk_bf16_f32 v76, v48, v49
    v_exp_f32 v52, v52
    v_exp_f32 v53, v53
    v_cvt_pk_bf16_f32 v77, v50, v51
    v_smfmac_f32_16x16x64_bf16 v[104:107], v[124:127], v[80:87], v215
    v_exp_f32 v54, v54
    v_exp_f32 v55, v55
    v_cvt_pk_bf16_f32 v78, v52, v53
    v_cvt_pk_bf16_f32 v79, v54, v55
    s_waitcnt lgkmcnt(2)
    v_mfma_f32_32x32x16_bf16 v[40:55], v[24:27], v[16:19], v[108:123]
    v_exp_f32 v56, v56
    v_exp_f32 v57, v57
    v_exp_f32 v58, v58
    v_exp_f32 v59, v59
    v_mfma_f32_32x32x16_bf16 v[40:55], v[28:31], v[20:23], v[40:55]
    ds_read_b128 v[24:27], v129 offset:4096
    ds_read_b128 v[28:31], v129 offset:5120
    v_cvt_pk_bf16_f32 v80, v56, v57
    v_exp_f32 v60, v60
    v_exp_f32 v61, v61
    v_cvt_pk_bf16_f32 v81, v58, v59
    s_waitcnt lgkmcnt(2)
    v_mfma_f32_32x32x16_bf16 v[88:103], v[32:35], v[72:75], v[88:103]
    v_exp_f32 v62, v62
    v_exp_f32 v63, v63
    v_cvt_pk_bf16_f32 v82, v60, v61
    v_exp_f32 v64, v64
    buffer_load_dwordx4 v130, s[8:11], s36 offen offset:1024 sc1 lds
    s_and_b32 s37, s37, 65535
    s_add_u32 s36, s36, 16384
    buffer_store_dwordx4 v[152:155], v233, s[8:11], s84 offen offset:3072 sc1
    v_exp_f32 v65, v65
    v_cvt_pk_bf16_f32 v83, v62, v63
    v_exp_f32 v66, v66
    v_exp_f32 v67, v67
    v_mfma_f32_32x32x16_bf16 v[88:103], v[36:39], v[76:79], v[88:103]
    ds_read_b128 v[32:35], v128 offset:14336
    ds_read_b128 v[36:39], v128 offset:15360
    v_cvt_pk_bf16_f32 v84, v64, v65
    v_exp_f32 v68, v68
    v_exp_f32 v69, v69
    v_cvt_pk_bf16_f32 v85, v66, v67
    v_smfmac_f32_16x16x64_bf16 v[104:107], v[124:127], v[72:79], v215
    v_exp_f32 v70, v70
    v_exp_f32 v71, v71
    v_cvt_pk_bf16_f32 v86, v68, v69
    v_cvt_pk_bf16_f32 v87, v70, v71
    v_mov_b32 v128, v129
    v_add_u32 v129, 16384, v129
    v_and_b32 v129, 65535, v129
    s_waitcnt lgkmcnt(2)
    v_mfma_f32_32x32x16_bf16 v[56:71], v[24:27], v[16:19], v[108:123]
    v_exp_f32 v40, v40
    v_exp_f32 v41, v41
    v_exp_f32 v42, v42
    v_exp_f32 v43, v43
    v_mfma_f32_32x32x16_bf16 v[56:71], v[28:31], v[20:23], v[56:71]
    ds_read_b128 v[24:27], v128 offset:8192
    ds_read_b128 v[28:31], v128 offset:9216
    v_cvt_pk_bf16_f32 v72, v40, v41
    v_exp_f32 v44, v44
    v_exp_f32 v45, v45
    v_cvt_pk_bf16_f32 v73, v42, v43
    s_waitcnt lgkmcnt(2)
    v_mfma_f32_32x32x16_bf16 v[88:103], v[32:35], v[80:83], v[88:103]
    v_exp_f32 v46, v46
    v_exp_f32 v47, v47
    v_cvt_pk_bf16_f32 v74, v44, v45
    v_exp_f32 v48, v48
    buffer_store_dwordx4 v[164:167], v233, s[8:11], s85 offen offset:0 sc1
    v_exp_f32 v49, v49
    v_cvt_pk_bf16_f32 v75, v46, v47
    v_exp_f32 v50, v50
    v_exp_f32 v51, v51
    v_mfma_f32_32x32x16_bf16 v[88:103], v[36:39], v[84:87], v[88:103]
    ds_read_b128 v[32:35], v128 offset:2048
    ds_read_b128 v[36:39], v128 offset:3072
    v_cvt_pk_bf16_f32 v76, v48, v49
    v_exp_f32 v52, v52
    v_exp_f32 v53, v53
    v_cvt_pk_bf16_f32 v77, v50, v51
    v_smfmac_f32_16x16x64_bf16 v[104:107], v[124:127], v[80:87], v215
    v_exp_f32 v54, v54
    v_exp_f32 v55, v55
    v_cvt_pk_bf16_f32 v78, v52, v53
    v_cvt_pk_bf16_f32 v79, v54, v55
    s_waitcnt lgkmcnt(2)
    v_mfma_f32_32x32x16_bf16 v[40:55], v[24:27], v[16:19], v[108:123]
    v_exp_f32 v56, v56
    v_exp_f32 v57, v57
    v_exp_f32 v58, v58
    v_exp_f32 v59, v59
    v_mfma_f32_32x32x16_bf16 v[40:55], v[28:31], v[20:23], v[40:55]
    ds_read_b128 v[24:27], v128 offset:12288
    ds_read_b128 v[28:31], v128 offset:13312
    v_cvt_pk_bf16_f32 v80, v56, v57
    v_exp_f32 v60, v60
    v_exp_f32 v61, v61
    v_cvt_pk_bf16_f32 v81, v58, v59
    s_waitcnt lgkmcnt(2)
    v_mfma_f32_32x32x16_bf16 v[88:103], v[32:35], v[72:75], v[88:103]
    v_exp_f32 v62, v62
    v_exp_f32 v63, v63
    v_cvt_pk_bf16_f32 v82, v60, v61
    v_exp_f32 v64, v64
    buffer_store_dwordx4 v[168:171], v233, s[8:11], s85 offen offset:1024 sc1
    v_exp_f32 v65, v65
    v_cvt_pk_bf16_f32 v83, v62, v63
    v_exp_f32 v66, v66
    v_exp_f32 v67, v67
    v_mfma_f32_32x32x16_bf16 v[88:103], v[36:39], v[76:79], v[88:103]
    ds_read_b128 v[32:35], v128 offset:6144
    ds_read_b128 v[36:39], v128 offset:7168
    v_cvt_pk_bf16_f32 v84, v64, v65
    v_exp_f32 v68, v68
    v_exp_f32 v69, v69
    v_cvt_pk_bf16_f32 v85, v66, v67
    v_smfmac_f32_16x16x64_bf16 v[104:107], v[124:127], v[72:79], v215
    v_exp_f32 v70, v70
    v_exp_f32 v71, v71
    v_cvt_pk_bf16_f32 v86, v68, v69
    v_cvt_pk_bf16_f32 v87, v70, v71
    s_waitcnt vmcnt(8)
    s_barrier
    s_waitcnt lgkmcnt(2)
    v_mfma_f32_32x32x16_bf16 v[56:71], v[24:27], v[16:19], v[108:123]
    v_exp_f32 v40, v40
    v_exp_f32 v41, v41
    v_exp_f32 v42, v42
    v_exp_f32 v43, v43
    v_mfma_f32_32x32x16_bf16 v[56:71], v[28:31], v[20:23], v[56:71]
    ds_read_b128 v[24:27], v129 offset:0
    ds_read_b128 v[28:31], v129 offset:1024
    v_cvt_pk_bf16_f32 v72, v40, v41
    v_exp_f32 v44, v44
    v_exp_f32 v45, v45
    v_cvt_pk_bf16_f32 v73, v42, v43
    s_waitcnt lgkmcnt(2)
    v_mfma_f32_32x32x16_bf16 v[88:103], v[32:35], v[80:83], v[88:103]
    v_exp_f32 v46, v46
    v_exp_f32 v47, v47
    v_cvt_pk_bf16_f32 v74, v44, v45
    v_exp_f32 v48, v48
    s_add_u32 m0, s37, s39
    s_add_u32 s37, s37, 16384
    buffer_load_dwordx4 v130, s[8:11], s36 offen sc1 lds
    buffer_store_dwordx4 v[180:183], v233, s[8:11], s85 offen offset:2048 sc1
    v_exp_f32 v49, v49
    v_cvt_pk_bf16_f32 v75, v46, v47
    v_exp_f32 v50, v50
    v_exp_f32 v51, v51
    v_mfma_f32_32x32x16_bf16 v[88:103], v[36:39], v[84:87], v[88:103]
    ds_read_b128 v[32:35], v128 offset:10240
    ds_read_b128 v[36:39], v128 offset:11264
    v_cvt_pk_bf16_f32 v76, v48, v49
    v_exp_f32 v52, v52
    v_exp_f32 v53, v53
    v_cvt_pk_bf16_f32 v77, v50, v51
    v_smfmac_f32_16x16x64_bf16 v[104:107], v[124:127], v[80:87], v215
    v_exp_f32 v54, v54
    v_exp_f32 v55, v55
    v_cvt_pk_bf16_f32 v78, v52, v53
    v_cvt_pk_bf16_f32 v79, v54, v55
    s_waitcnt lgkmcnt(2)
    v_mfma_f32_32x32x16_bf16 v[40:55], v[24:27], v[16:19], v[108:123]
    v_exp_f32 v56, v56
    v_exp_f32 v57, v57
    v_exp_f32 v58, v58
    v_exp_f32 v59, v59
    v_mfma_f32_32x32x16_bf16 v[40:55], v[28:31], v[20:23], v[40:55]
    ds_read_b128 v[24:27], v129 offset:4096
    ds_read_b128 v[28:31], v129 offset:5120
    v_cvt_pk_bf16_f32 v80, v56, v57
    v_exp_f32 v60, v60
    v_exp_f32 v61, v61
    v_cvt_pk_bf16_f32 v81, v58, v59
    s_waitcnt lgkmcnt(2)
    v_mfma_f32_32x32x16_bf16 v[88:103], v[32:35], v[72:75], v[88:103]
    v_exp_f32 v62, v62
    v_exp_f32 v63, v63
    v_cvt_pk_bf16_f32 v82, v60, v61
    v_exp_f32 v64, v64
    buffer_load_dwordx4 v130, s[8:11], s36 offen offset:1024 sc1 lds
    s_and_b32 s37, s37, 65535
    s_add_u32 s36, s36, 16384
    buffer_store_dwordx4 v[184:187], v233, s[8:11], s85 offen offset:3072 sc1
    v_exp_f32 v65, v65
    v_cvt_pk_bf16_f32 v83, v62, v63
    v_exp_f32 v66, v66
    v_exp_f32 v67, v67
    v_mfma_f32_32x32x16_bf16 v[88:103], v[36:39], v[76:79], v[88:103]
    ds_read_b128 v[32:35], v128 offset:14336
    ds_read_b128 v[36:39], v128 offset:15360
    v_cvt_pk_bf16_f32 v84, v64, v65
    v_exp_f32 v68, v68
    v_exp_f32 v69, v69
    v_cvt_pk_bf16_f32 v85, v66, v67
    v_smfmac_f32_16x16x64_bf16 v[104:107], v[124:127], v[72:79], v215
    v_exp_f32 v70, v70
    v_exp_f32 v71, v71
    v_cvt_pk_bf16_f32 v86, v68, v69
    v_cvt_pk_bf16_f32 v87, v70, v71
    v_mov_b32 v128, v129
    v_add_u32 v129, 16384, v129
    v_and_b32 v129, 65535, v129
    s_waitcnt lgkmcnt(2)
    v_mfma_f32_32x32x16_bf16 v[56:71], v[24:27], v[16:19], v[108:123]
    v_exp_f32 v40, v40
    v_exp_f32 v41, v41
    v_exp_f32 v42, v42
    v_exp_f32 v43, v43
    v_mfma_f32_32x32x16_bf16 v[56:71], v[28:31], v[20:23], v[56:71]
    ds_read_b128 v[24:27], v128 offset:8192
    ds_read_b128 v[28:31], v128 offset:9216
    v_cvt_pk_bf16_f32 v72, v40, v41
    v_exp_f32 v44, v44
    v_exp_f32 v45, v45
    v_cvt_pk_bf16_f32 v73, v42, v43
    s_waitcnt lgkmcnt(2)
    v_mfma_f32_32x32x16_bf16 v[88:103], v[32:35], v[80:83], v[88:103]
    v_exp_f32 v46, v46
    v_exp_f32 v47, v47
    v_cvt_pk_bf16_f32 v74, v44, v45
    v_exp_f32 v48, v48
    v_exp_f32 v49, v49
    v_cvt_pk_bf16_f32 v75, v46, v47
    v_exp_f32 v50, v50
    v_exp_f32 v51, v51
    v_mfma_f32_32x32x16_bf16 v[88:103], v[36:39], v[84:87], v[88:103]
    ds_read_b128 v[32:35], v128 offset:2048
    ds_read_b128 v[36:39], v128 offset:3072
    v_cvt_pk_bf16_f32 v76, v48, v49
    v_exp_f32 v52, v52
    v_exp_f32 v53, v53
    v_cvt_pk_bf16_f32 v77, v50, v51
    v_smfmac_f32_16x16x64_bf16 v[104:107], v[124:127], v[80:87], v215
    v_exp_f32 v54, v54
    v_exp_f32 v55, v55
    v_cvt_pk_bf16_f32 v78, v52, v53
    v_cvt_pk_bf16_f32 v79, v54, v55
    s_waitcnt lgkmcnt(2)
    v_mfma_f32_32x32x16_bf16 v[40:55], v[24:27], v[16:19], v[108:123]
    v_exp_f32 v56, v56
    v_exp_f32 v57, v57
    v_exp_f32 v58, v58
    v_exp_f32 v59, v59
    v_mfma_f32_32x32x16_bf16 v[40:55], v[28:31], v[20:23], v[40:55]
    ds_read_b128 v[24:27], v128 offset:12288
    ds_read_b128 v[28:31], v128 offset:13312
    v_cvt_pk_bf16_f32 v80, v56, v57
    v_exp_f32 v60, v60
    v_exp_f32 v61, v61
    v_cvt_pk_bf16_f32 v81, v58, v59
    s_waitcnt lgkmcnt(2)
    v_mfma_f32_32x32x16_bf16 v[88:103], v[32:35], v[72:75], v[88:103]
    v_exp_f32 v62, v62
    v_exp_f32 v63, v63
    v_cvt_pk_bf16_f32 v82, v60, v61
    v_exp_f32 v64, v64
    v_exp_f32 v65, v65
    v_cvt_pk_bf16_f32 v83, v62, v63
    v_exp_f32 v66, v66
    v_exp_f32 v67, v67
    v_mfma_f32_32x32x16_bf16 v[88:103], v[36:39], v[76:79], v[88:103]
    ds_read_b128 v[32:35], v128 offset:6144
    ds_read_b128 v[36:39], v128 offset:7168
    v_cvt_pk_bf16_f32 v84, v64, v65
    v_exp_f32 v68, v68
    v_exp_f32 v69, v69
    v_cvt_pk_bf16_f32 v85, v66, v67
    v_smfmac_f32_16x16x64_bf16 v[104:107], v[124:127], v[72:79], v215
    v_exp_f32 v70, v70
    v_exp_f32 v71, v71
    v_cvt_pk_bf16_f32 v86, v68, v69
    v_cvt_pk_bf16_f32 v87, v70, v71
    s_waitcnt vmcnt(7)
    s_barrier
    s_waitcnt lgkmcnt(2)
    v_mfma_f32_32x32x16_bf16 v[56:71], v[24:27], v[16:19], v[108:123]
    v_exp_f32 v40, v40
    v_exp_f32 v41, v41
    v_exp_f32 v42, v42
    v_exp_f32 v43, v43
    v_mfma_f32_32x32x16_bf16 v[56:71], v[28:31], v[20:23], v[56:71]
    ds_read_b128 v[24:27], v129 offset:0
    ds_read_b128 v[28:31], v129 offset:1024
    v_cvt_pk_bf16_f32 v72, v40, v41
    v_exp_f32 v44, v44
    v_exp_f32 v45, v45
    v_cvt_pk_bf16_f32 v73, v42, v43
    s_waitcnt lgkmcnt(2)
    v_mfma_f32_32x32x16_bf16 v[88:103], v[32:35], v[80:83], v[88:103]
    v_exp_f32 v46, v46
    v_exp_f32 v47, v47
    v_cvt_pk_bf16_f32 v74, v44, v45
    v_exp_f32 v48, v48
    s_add_u32 m0, s37, s39
    s_add_u32 s37, s37, 16384
    buffer_load_dwordx4 v130, s[8:11], s36 offen sc1 lds
    v_exp_f32 v49, v49
    v_cvt_pk_bf16_f32 v75, v46, v47
    v_exp_f32 v50, v50
    v_exp_f32 v51, v51
    v_mfma_f32_32x32x16_bf16 v[88:103], v[36:39], v[84:87], v[88:103]
    ds_read_b128 v[32:35], v128 offset:10240
    ds_read_b128 v[36:39], v128 offset:11264
    v_cvt_pk_bf16_f32 v76, v48, v49
    v_exp_f32 v52, v52
    v_exp_f32 v53, v53
    v_cvt_pk_bf16_f32 v77, v50, v51
    v_smfmac_f32_16x16x64_bf16 v[104:107], v[124:127], v[80:87], v215
    v_exp_f32 v54, v54
    v_exp_f32 v55, v55
    v_cvt_pk_bf16_f32 v78, v52, v53
    v_cvt_pk_bf16_f32 v79, v54, v55
    s_waitcnt lgkmcnt(2)
    v_mfma_f32_32x32x16_bf16 v[40:55], v[24:27], v[16:19], v[108:123]
    v_exp_f32 v56, v56
    v_exp_f32 v57, v57
    v_exp_f32 v58, v58
    v_exp_f32 v59, v59
    v_mfma_f32_32x32x16_bf16 v[40:55], v[28:31], v[20:23], v[40:55]
    ds_read_b128 v[24:27], v129 offset:4096
    ds_read_b128 v[28:31], v129 offset:5120
    v_cvt_pk_bf16_f32 v80, v56, v57
    v_exp_f32 v60, v60
    v_exp_f32 v61, v61
    v_cvt_pk_bf16_f32 v81, v58, v59
    s_waitcnt lgkmcnt(2)
    v_mfma_f32_32x32x16_bf16 v[88:103], v[32:35], v[72:75], v[88:103]
    v_exp_f32 v62, v62
    v_exp_f32 v63, v63
    v_cvt_pk_bf16_f32 v82, v60, v61
    v_exp_f32 v64, v64
    buffer_load_dwordx4 v130, s[8:11], s36 offen offset:1024 sc1 lds
    s_and_b32 s37, s37, 65535
    s_add_u32 s36, s36, 16384
    v_exp_f32 v65, v65
    v_cvt_pk_bf16_f32 v83, v62, v63
    v_exp_f32 v66, v66
    v_exp_f32 v67, v67
    v_mfma_f32_32x32x16_bf16 v[88:103], v[36:39], v[76:79], v[88:103]
    ds_read_b128 v[32:35], v128 offset:14336
    ds_read_b128 v[36:39], v128 offset:15360
    v_cvt_pk_bf16_f32 v84, v64, v65
    v_exp_f32 v68, v68
    v_exp_f32 v69, v69
    v_cvt_pk_bf16_f32 v85, v66, v67
    v_smfmac_f32_16x16x64_bf16 v[104:107], v[124:127], v[72:79], v215
    v_exp_f32 v70, v70
    v_exp_f32 v71, v71
    v_cvt_pk_bf16_f32 v86, v68, v69
    v_cvt_pk_bf16_f32 v87, v70, v71
    v_mov_b32 v128, v129
    v_add_u32 v129, 16384, v129
    v_and_b32 v129, 65535, v129
    s_waitcnt lgkmcnt(2)
    v_mfma_f32_32x32x16_bf16 v[56:71], v[24:27], v[16:19], v[108:123]
    v_exp_f32 v40, v40
    v_exp_f32 v41, v41
    v_exp_f32 v42, v42
    v_exp_f32 v43, v43
    v_mfma_f32_32x32x16_bf16 v[56:71], v[28:31], v[20:23], v[56:71]
    ds_read_b128 v[24:27], v128 offset:8192
    ds_read_b128 v[28:31], v128 offset:9216
    v_cvt_pk_bf16_f32 v72, v40, v41
    v_exp_f32 v44, v44
    v_exp_f32 v45, v45
    v_cvt_pk_bf16_f32 v73, v42, v43
    s_waitcnt lgkmcnt(2)
    v_mfma_f32_32x32x16_bf16 v[88:103], v[32:35], v[80:83], v[88:103]
    v_exp_f32 v46, v46
    v_exp_f32 v47, v47
    v_cvt_pk_bf16_f32 v74, v44, v45
    v_exp_f32 v48, v48
    v_exp_f32 v49, v49
    v_cvt_pk_bf16_f32 v75, v46, v47
    v_exp_f32 v50, v50
    v_exp_f32 v51, v51
    v_mfma_f32_32x32x16_bf16 v[88:103], v[36:39], v[84:87], v[88:103]
    ds_read_b128 v[32:35], v128 offset:2048
    ds_read_b128 v[36:39], v128 offset:3072
    v_cvt_pk_bf16_f32 v76, v48, v49
    v_exp_f32 v52, v52
    v_exp_f32 v53, v53
    v_cvt_pk_bf16_f32 v77, v50, v51
    v_smfmac_f32_16x16x64_bf16 v[104:107], v[124:127], v[80:87], v215
    v_exp_f32 v54, v54
    v_exp_f32 v55, v55
    v_cvt_pk_bf16_f32 v78, v52, v53
    v_cvt_pk_bf16_f32 v79, v54, v55
    s_waitcnt lgkmcnt(2)
    v_mfma_f32_32x32x16_bf16 v[40:55], v[24:27], v[16:19], v[108:123]
    v_exp_f32 v56, v56
    v_exp_f32 v57, v57
    v_exp_f32 v58, v58
    v_exp_f32 v59, v59
    v_mfma_f32_32x32x16_bf16 v[40:55], v[28:31], v[20:23], v[40:55]
    ds_read_b128 v[24:27], v128 offset:12288
    ds_read_b128 v[28:31], v128 offset:13312
    v_cvt_pk_bf16_f32 v80, v56, v57
    v_exp_f32 v60, v60
    v_exp_f32 v61, v61
    v_cvt_pk_bf16_f32 v81, v58, v59
    s_waitcnt lgkmcnt(2)
    v_mfma_f32_32x32x16_bf16 v[88:103], v[32:35], v[72:75], v[88:103]
    v_exp_f32 v62, v62
    v_exp_f32 v63, v63
    v_cvt_pk_bf16_f32 v82, v60, v61
    v_exp_f32 v64, v64
    v_exp_f32 v65, v65
    v_cvt_pk_bf16_f32 v83, v62, v63
    v_exp_f32 v66, v66
    v_exp_f32 v67, v67
    v_mfma_f32_32x32x16_bf16 v[88:103], v[36:39], v[76:79], v[88:103]
    ds_read_b128 v[32:35], v128 offset:6144
    ds_read_b128 v[36:39], v128 offset:7168
    v_cvt_pk_bf16_f32 v84, v64, v65
    v_exp_f32 v68, v68
    v_exp_f32 v69, v69
    v_cvt_pk_bf16_f32 v85, v66, v67
    v_smfmac_f32_16x16x64_bf16 v[104:107], v[124:127], v[72:79], v215
    v_exp_f32 v70, v70
    v_exp_f32 v71, v71
    v_cvt_pk_bf16_f32 v86, v68, v69
    v_cvt_pk_bf16_f32 v87, v70, v71
    s_waitcnt vmcnt(3)
    s_barrier
    buffer_store_dword v255, v224, s[8:11], s93 offen sc1
    s_waitcnt lgkmcnt(2)
    v_mfma_f32_32x32x16_bf16 v[56:71], v[24:27], v[16:19], v[108:123]
    v_exp_f32 v40, v40
    v_exp_f32 v41, v41
    v_exp_f32 v42, v42
    v_exp_f32 v43, v43
    v_mfma_f32_32x32x16_bf16 v[56:71], v[28:31], v[20:23], v[56:71]
    ds_read_b128 v[24:27], v129 offset:0
    ds_read_b128 v[28:31], v129 offset:1024
    v_cvt_pk_bf16_f32 v72, v40, v41
    v_exp_f32 v44, v44
    v_exp_f32 v45, v45
    v_cvt_pk_bf16_f32 v73, v42, v43
    s_waitcnt lgkmcnt(2)
    v_mfma_f32_32x32x16_bf16 v[88:103], v[32:35], v[80:83], v[88:103]
    v_exp_f32 v46, v46
    v_exp_f32 v47, v47
    v_cvt_pk_bf16_f32 v74, v44, v45
    v_exp_f32 v48, v48
    s_add_u32 m0, s37, s39
    s_add_u32 s37, s37, 16384
    buffer_load_dwordx4 v130, s[8:11], s36 offen sc1 lds
    v_exp_f32 v49, v49
    v_cvt_pk_bf16_f32 v75, v46, v47
    v_exp_f32 v50, v50
    v_exp_f32 v51, v51
    v_mfma_f32_32x32x16_bf16 v[88:103], v[36:39], v[84:87], v[88:103]
    ds_read_b128 v[32:35], v128 offset:10240
    ds_read_b128 v[36:39], v128 offset:11264
    v_cvt_pk_bf16_f32 v76, v48, v49
    v_exp_f32 v52, v52
    v_exp_f32 v53, v53
    v_cvt_pk_bf16_f32 v77, v50, v51
    v_smfmac_f32_16x16x64_bf16 v[104:107], v[124:127], v[80:87], v215
    v_exp_f32 v54, v54
    v_exp_f32 v55, v55
    v_cvt_pk_bf16_f32 v78, v52, v53
    v_cvt_pk_bf16_f32 v79, v54, v55
    s_waitcnt lgkmcnt(2)
    v_mfma_f32_32x32x16_bf16 v[40:55], v[24:27], v[16:19], v[108:123]
    v_exp_f32 v56, v56
    v_exp_f32 v57, v57
    v_exp_f32 v58, v58
    v_exp_f32 v59, v59
    v_mfma_f32_32x32x16_bf16 v[40:55], v[28:31], v[20:23], v[40:55]
    ds_read_b128 v[24:27], v129 offset:4096
    ds_read_b128 v[28:31], v129 offset:5120
    v_cvt_pk_bf16_f32 v80, v56, v57
    v_exp_f32 v60, v60
    v_exp_f32 v61, v61
    v_cvt_pk_bf16_f32 v81, v58, v59
    s_waitcnt lgkmcnt(2)
    v_mfma_f32_32x32x16_bf16 v[88:103], v[32:35], v[72:75], v[88:103]
    v_exp_f32 v62, v62
    v_exp_f32 v63, v63
    v_cvt_pk_bf16_f32 v82, v60, v61
    v_exp_f32 v64, v64
    buffer_load_dwordx4 v130, s[8:11], s36 offen offset:1024 sc1 lds
    s_and_b32 s37, s37, 65535
    s_add_u32 s36, s36, 16384
    v_exp_f32 v65, v65
    v_cvt_pk_bf16_f32 v83, v62, v63
    v_exp_f32 v66, v66
    v_exp_f32 v67, v67
    v_mfma_f32_32x32x16_bf16 v[88:103], v[36:39], v[76:79], v[88:103]
    ds_read_b128 v[32:35], v128 offset:14336
    ds_read_b128 v[36:39], v128 offset:15360
    v_cvt_pk_bf16_f32 v84, v64, v65
    v_exp_f32 v68, v68
    v_exp_f32 v69, v69
    v_cvt_pk_bf16_f32 v85, v66, v67
    v_smfmac_f32_16x16x64_bf16 v[104:107], v[124:127], v[72:79], v215
    v_exp_f32 v70, v70
    v_exp_f32 v71, v71
    v_cvt_pk_bf16_f32 v86, v68, v69
    v_cvt_pk_bf16_f32 v87, v70, v71
    v_mov_b32 v128, v129
    v_add_u32 v129, 16384, v129
    v_and_b32 v129, 65535, v129
    s_waitcnt lgkmcnt(2)
    v_mfma_f32_32x32x16_bf16 v[56:71], v[24:27], v[16:19], v[108:123]
    v_exp_f32 v40, v40
    v_exp_f32 v41, v41
    v_exp_f32 v42, v42
    v_exp_f32 v43, v43
    v_mfma_f32_32x32x16_bf16 v[56:71], v[28:31], v[20:23], v[56:71]
    ds_read_b128 v[24:27], v128 offset:8192
    ds_read_b128 v[28:31], v128 offset:9216
    v_cvt_pk_bf16_f32 v72, v40, v41
    v_exp_f32 v44, v44
    v_exp_f32 v45, v45
    v_cvt_pk_bf16_f32 v73, v42, v43
    s_waitcnt lgkmcnt(2)
    v_mfma_f32_32x32x16_bf16 v[88:103], v[32:35], v[80:83], v[88:103]
    v_exp_f32 v46, v46
    v_exp_f32 v47, v47
    v_cvt_pk_bf16_f32 v74, v44, v45
    v_exp_f32 v48, v48
    buffer_load_dword v228, v226, s[8:11], s100 offen sc1
    v_exp_f32 v49, v49
    v_cvt_pk_bf16_f32 v75, v46, v47
    v_exp_f32 v50, v50
    v_exp_f32 v51, v51
    v_mfma_f32_32x32x16_bf16 v[88:103], v[36:39], v[84:87], v[88:103]
    ds_read_b128 v[32:35], v128 offset:2048
    ds_read_b128 v[36:39], v128 offset:3072
    v_cvt_pk_bf16_f32 v76, v48, v49
    v_exp_f32 v52, v52
    v_exp_f32 v53, v53
    v_cvt_pk_bf16_f32 v77, v50, v51
    v_smfmac_f32_16x16x64_bf16 v[104:107], v[124:127], v[80:87], v215
    v_exp_f32 v54, v54
    v_exp_f32 v55, v55
    v_cvt_pk_bf16_f32 v78, v52, v53
    v_cvt_pk_bf16_f32 v79, v54, v55
    s_waitcnt lgkmcnt(2)
    v_mfma_f32_32x32x16_bf16 v[40:55], v[24:27], v[16:19], v[108:123]
    v_exp_f32 v56, v56
    v_exp_f32 v57, v57
    v_exp_f32 v58, v58
    v_exp_f32 v59, v59
    v_mfma_f32_32x32x16_bf16 v[40:55], v[28:31], v[20:23], v[40:55]
    ds_read_b128 v[24:27], v128 offset:12288
    ds_read_b128 v[28:31], v128 offset:13312
    v_cvt_pk_bf16_f32 v80, v56, v57
    v_exp_f32 v60, v60
    v_exp_f32 v61, v61
    v_cvt_pk_bf16_f32 v81, v58, v59
    s_waitcnt lgkmcnt(2)
    v_mfma_f32_32x32x16_bf16 v[88:103], v[32:35], v[72:75], v[88:103]
    v_exp_f32 v62, v62
    v_exp_f32 v63, v63
    v_cvt_pk_bf16_f32 v82, v60, v61
    v_exp_f32 v64, v64
    v_exp_f32 v65, v65
    v_cvt_pk_bf16_f32 v83, v62, v63
    v_exp_f32 v66, v66
    v_exp_f32 v67, v67
    v_mfma_f32_32x32x16_bf16 v[88:103], v[36:39], v[76:79], v[88:103]
    ds_read_b128 v[32:35], v128 offset:6144
    ds_read_b128 v[36:39], v128 offset:7168
    v_cvt_pk_bf16_f32 v84, v64, v65
    v_exp_f32 v68, v68
    v_exp_f32 v69, v69
    v_cvt_pk_bf16_f32 v85, v66, v67
    v_smfmac_f32_16x16x64_bf16 v[104:107], v[124:127], v[72:79], v215
    v_exp_f32 v70, v70
    v_exp_f32 v71, v71
    v_cvt_pk_bf16_f32 v86, v68, v69
    v_cvt_pk_bf16_f32 v87, v70, v71
    s_waitcnt vmcnt(4)
    s_barrier
    s_waitcnt lgkmcnt(2)
    v_mfma_f32_32x32x16_bf16 v[56:71], v[24:27], v[16:19], v[108:123]
    v_exp_f32 v40, v40
    v_exp_f32 v41, v41
    v_exp_f32 v42, v42
    v_exp_f32 v43, v43
    v_mfma_f32_32x32x16_bf16 v[56:71], v[28:31], v[20:23], v[56:71]
    ds_read_b128 v[24:27], v129 offset:0
    ds_read_b128 v[28:31], v129 offset:1024
    v_cvt_pk_bf16_f32 v72, v40, v41
    v_exp_f32 v44, v44
    v_exp_f32 v45, v45
    v_cvt_pk_bf16_f32 v73, v42, v43
    s_waitcnt lgkmcnt(2)
    v_mfma_f32_32x32x16_bf16 v[88:103], v[32:35], v[80:83], v[88:103]
    v_exp_f32 v46, v46
    v_exp_f32 v47, v47
    v_cvt_pk_bf16_f32 v74, v44, v45
    v_exp_f32 v48, v48
    s_add_u32 m0, s37, s39
    s_add_u32 s37, s37, 16384
    buffer_load_dwordx4 v130, s[8:11], s36 offen sc1 lds
    v_exp_f32 v49, v49
    v_cvt_pk_bf16_f32 v75, v46, v47
    v_exp_f32 v50, v50
    v_exp_f32 v51, v51
    v_mfma_f32_32x32x16_bf16 v[88:103], v[36:39], v[84:87], v[88:103]
    ds_read_b128 v[32:35], v128 offset:10240
    ds_read_b128 v[36:39], v128 offset:11264
    v_cvt_pk_bf16_f32 v76, v48, v49
    v_exp_f32 v52, v52
    v_exp_f32 v53, v53
    v_cvt_pk_bf16_f32 v77, v50, v51
    v_smfmac_f32_16x16x64_bf16 v[104:107], v[124:127], v[80:87], v215
    v_exp_f32 v54, v54
    v_exp_f32 v55, v55
    v_cvt_pk_bf16_f32 v78, v52, v53
    v_cvt_pk_bf16_f32 v79, v54, v55
    s_waitcnt lgkmcnt(2)
    v_mfma_f32_32x32x16_bf16 v[40:55], v[24:27], v[16:19], v[108:123]
    v_exp_f32 v56, v56
    v_exp_f32 v57, v57
    v_exp_f32 v58, v58
    v_exp_f32 v59, v59
    v_mfma_f32_32x32x16_bf16 v[40:55], v[28:31], v[20:23], v[40:55]
    ds_read_b128 v[24:27], v129 offset:4096
    ds_read_b128 v[28:31], v129 offset:5120
    v_cvt_pk_bf16_f32 v80, v56, v57
    v_exp_f32 v60, v60
    v_exp_f32 v61, v61
    v_cvt_pk_bf16_f32 v81, v58, v59
    s_waitcnt lgkmcnt(2)
    v_mfma_f32_32x32x16_bf16 v[88:103], v[32:35], v[72:75], v[88:103]
    v_exp_f32 v62, v62
    v_exp_f32 v63, v63
    v_cvt_pk_bf16_f32 v82, v60, v61
    v_exp_f32 v64, v64
    buffer_load_dwordx4 v130, s[8:11], s36 offen offset:1024 sc1 lds
    s_and_b32 s37, s37, 65535
    s_add_u32 s36, s36, 16384
    s_waitcnt vmcnt(2)
    v_cmp_ne_u32 vcc, 1, v228
    s_cbranch_vccnz M_GSPIN
M_GOK:
    v_exp_f32 v65, v65
    v_cvt_pk_bf16_f32 v83, v62, v63
    v_exp_f32 v66, v66
    v_exp_f32 v67, v67
    v_mfma_f32_32x32x16_bf16 v[88:103], v[36:39], v[76:79], v[88:103]
    ds_read_b128 v[32:35], v128 offset:14336
    ds_read_b128 v[36:39], v128 offset:15360
    v_cvt_pk_bf16_f32 v84, v64, v65
    v_exp_f32 v68, v68
    v_exp_f32 v69, v69
    v_cvt_pk_bf16_f32 v85, v66, v67
    v_smfmac_f32_16x16x64_bf16 v[104:107], v[124:127], v[72:79], v215
    v_exp_f32 v70, v70
    v_exp_f32 v71, v71
    v_cvt_pk_bf16_f32 v86, v68, v69
    v_cvt_pk_bf16_f32 v87, v70, v71
    v_mov_b32 v128, v129
    v_add_u32 v129, 16384, v129
    v_and_b32 v129, 65535, v129
    s_waitcnt lgkmcnt(2)
    v_mfma_f32_32x32x16_bf16 v[56:71], v[24:27], v[16:19], v[108:123]
    v_exp_f32 v40, v40
    v_exp_f32 v41, v41
    v_exp_f32 v42, v42
    v_exp_f32 v43, v43
    v_mfma_f32_32x32x16_bf16 v[56:71], v[28:31], v[20:23], v[56:71]
    ds_read_b128 v[24:27], v128 offset:8192
    ds_read_b128 v[28:31], v128 offset:9216
    v_cvt_pk_bf16_f32 v72, v40, v41
    v_exp_f32 v44, v44
    v_exp_f32 v45, v45
    v_cvt_pk_bf16_f32 v73, v42, v43
    buffer_load_dword v214, v213, s[8:11], s25 offen sc1
    s_waitcnt lgkmcnt(2)
    v_mfma_f32_32x32x16_bf16 v[88:103], v[32:35], v[80:83], v[88:103]
    v_exp_f32 v46, v46
    v_exp_f32 v47, v47
    v_cvt_pk_bf16_f32 v74, v44, v45
    v_exp_f32 v48, v48
    v_exp_f32 v49, v49
    v_cvt_pk_bf16_f32 v75, v46, v47
    v_exp_f32 v50, v50
    v_exp_f32 v51, v51
    buffer_load_dwordx4 v[132:135], v131, s[8:11], s22 offen offset:0 sc1
    v_mfma_f32_32x32x16_bf16 v[88:103], v[36:39], v[84:87], v[88:103]
    ds_read_b128 v[32:35], v128 offset:2048
    ds_read_b128 v[36:39], v128 offset:3072
    v_cvt_pk_bf16_f32 v76, v48, v49
    v_exp_f32 v52, v52
    v_exp_f32 v53, v53
    v_cvt_pk_bf16_f32 v77, v50, v51
    v_smfmac_f32_16x16x64_bf16 v[104:107], v[124:127], v[80:87], v215
    v_exp_f32 v54, v54
    v_exp_f32 v55, v55
    v_cvt_pk_bf16_f32 v78, v52, v53
    v_cvt_pk_bf16_f32 v79, v54, v55
    buffer_load_dwordx4 v[136:139], v131, s[8:11], s22 offen offset:1024 sc1
    s_waitcnt lgkmcnt(2)
    v_mfma_f32_32x32x16_bf16 v[40:55], v[24:27], v[16:19], v[108:123]
    v_exp_f32 v56, v56
    v_exp_f32 v57, v57
    v_exp_f32 v58, v58
    v_exp_f32 v59, v59
    v_mfma_f32_32x32x16_bf16 v[40:55], v[28:31], v[20:23], v[40:55]
    ds_read_b128 v[24:27], v128 offset:12288
    ds_read_b128 v[28:31], v128 offset:13312
    v_cvt_pk_bf16_f32 v80, v56, v57
    v_exp_f32 v60, v60
    v_exp_f32 v61, v61
    v_cvt_pk_bf16_f32 v81, v58, v59
    buffer_load_dwordx4 v[140:143], v131, s[8:11], s22 offen offset:2048 sc1
    s_waitcnt lgkmcnt(2)
    v_mfma_f32_32x32x16_bf16 v[88:103], v[32:35], v[72:75], v[88:103]
    v_exp_f32 v62, v62
    v_exp_f32 v63, v63
    v_cvt_pk_bf16_f32 v82, v60, v61
    v_exp_f32 v64, v64
    buffer_load_dwordx4 v[144:147], v131, s[8:11], s22 offen offset:3072 sc1
    v_exp_f32 v65, v65
    v_cvt_pk_bf16_f32 v83, v62, v63
    v_exp_f32 v66, v66
    v_exp_f32 v67, v67
    v_mfma_f32_32x32x16_bf16 v[88:103], v[36:39], v[76:79], v[88:103]
    ds_read_b128 v[32:35], v128 offset:6144
    ds_read_b128 v[36:39], v128 offset:7168
    v_cvt_pk_bf16_f32 v84, v64, v65
    v_exp_f32 v68, v68
    v_exp_f32 v69, v69
    v_cvt_pk_bf16_f32 v85, v66, v67
    buffer_load_dwordx4 v[148:151], v131, s[8:11], s20 offen sc1
    v_smfmac_f32_16x16x64_bf16 v[104:107], v[124:127], v[72:79], v215
    v_exp_f32 v70, v70
    v_exp_f32 v71, v71
    v_cvt_pk_bf16_f32 v86, v68, v69
    v_cvt_pk_bf16_f32 v87, v70, v71
    s_add_u32 s20, s20, 8192
    s_barrier
    s_waitcnt lgkmcnt(2)
    v_mfma_f32_32x32x16_bf16 v[56:71], v[24:27], v[16:19], v[108:123]
    v_exp_f32 v40, v40
    v_exp_f32 v41, v41
    v_exp_f32 v42, v42
    v_exp_f32 v43, v43
    buffer_load_dwordx4 v[152:155], v131, s[8:11], s20 offen sc1
    v_mfma_f32_32x32x16_bf16 v[56:71], v[28:31], v[20:23], v[56:71]
    ds_read_b128 v[24:27], v129 offset:0
    ds_read_b128 v[28:31], v129 offset:1024
    v_cvt_pk_bf16_f32 v72, v40, v41
    v_exp_f32 v44, v44
    v_exp_f32 v45, v45
    v_cvt_pk_bf16_f32 v73, v42, v43
    s_add_u32 s20, s20, 8192
    s_waitcnt lgkmcnt(2)
    v_mfma_f32_32x32x16_bf16 v[88:103], v[32:35], v[80:83], v[88:103]
    v_exp_f32 v46, v46
    v_exp_f32 v47, v47
    v_cvt_pk_bf16_f32 v74, v44, v45
    v_exp_f32 v48, v48
    buffer_load_dwordx4 v[156:159], v131, s[8:11], s20 offen sc1
    s_add_u32 m0, s37, s39
    s_add_u32 s37, s37, 16384
    buffer_load_dwordx4 v130, s[8:11], s36 offen sc1 lds
    v_exp_f32 v49, v49
    v_cvt_pk_bf16_f32 v75, v46, v47
    v_exp_f32 v50, v50
    v_exp_f32 v51, v51
    s_add_u32 s20, s20, 8192
    v_mfma_f32_32x32x16_bf16 v[88:103], v[36:39], v[84:87], v[88:103]
    ds_read_b128 v[32:35], v128 offset:10240
    ds_read_b128 v[36:39], v128 offset:11264
    v_cvt_pk_bf16_f32 v76, v48, v49
    v_exp_f32 v52, v52
    v_exp_f32 v53, v53
    v_cvt_pk_bf16_f32 v77, v50, v51
    buffer_load_dwordx4 v[160:163], v131, s[8:11], s20 offen sc1
    v_smfmac_f32_16x16x64_bf16 v[104:107], v[124:127], v[80:87], v215
    v_exp_f32 v54, v54
    v_exp_f32 v55, v55
    v_cvt_pk_bf16_f32 v78, v52, v53
    v_cvt_pk_bf16_f32 v79, v54, v55
    s_add_u32 s20, s20, 8192
    s_waitcnt lgkmcnt(2)
    v_mfma_f32_32x32x16_bf16 v[40:55], v[24:27], v[16:19], v[108:123]
    v_exp_f32 v56, v56
    v_exp_f32 v57, v57
    v_exp_f32 v58, v58
    v_exp_f32 v59, v59
    buffer_load_dwordx4 v[164:167], v131, s[8:11], s20 offen sc1
    v_mfma_f32_32x32x16_bf16 v[40:55], v[28:31], v[20:23], v[40:55]
    ds_read_b128 v[24:27], v129 offset:4096
    ds_read_b128 v[28:31], v129 offset:5120
    v_cvt_pk_bf16_f32 v80, v56, v57
    v_exp_f32 v60, v60
    v_exp_f32 v61, v61
    v_cvt_pk_bf16_f32 v81, v58, v59
    s_add_u32 s20, s20, 8192
    s_waitcnt lgkmcnt(2)
    v_mfma_f32_32x32x16_bf16 v[88:103], v[32:35], v[72:75], v[88:103]
    v_exp_f32 v62, v62
    v_exp_f32 v63, v63
    v_cvt_pk_bf16_f32 v82, v60, v61
    v_exp_f32 v64, v64
    buffer_load_dwordx4 v[168:171], v131, s[8:11], s20 offen sc1
    buffer_load_dwordx4 v130, s[8:11], s36 offen offset:1024 sc1 lds
    s_and_b32 s37, s37, 65535
    s_add_u32 s36, s36, 16384
    v_exp_f32 v65, v65
    v_cvt_pk_bf16_f32 v83, v62, v63
    v_exp_f32 v66, v66
    v_exp_f32 v67, v67
    s_add_u32 s20, s20, 8192
    v_mfma_f32_32x32x16_bf16 v[88:103], v[36:39], v[76:79], v[88:103]
    ds_read_b128 v[32:35], v128 offset:14336
    ds_read_b128 v[36:39], v128 offset:15360
    v_cvt_pk_bf16_f32 v84, v64, v65
    v_exp_f32 v68, v68
    v_exp_f32 v69, v69
    v_cvt_pk_bf16_f32 v85, v66, v67
    buffer_load_dwordx4 v[172:175], v131, s[8:11], s20 offen sc1
    v_smfmac_f32_16x16x64_bf16 v[104:107], v[124:127], v[72:79], v215
    v_exp_f32 v70, v70
    v_exp_f32 v71, v71
    v_cvt_pk_bf16_f32 v86, v68, v69
    v_cvt_pk_bf16_f32 v87, v70, v71
    s_add_u32 s20, s20, 8192
    v_mov_b32 v128, v129
    v_add_u32 v129, 16384, v129
    v_and_b32 v129, 65535, v129
    s_waitcnt lgkmcnt(2)
    v_mfma_f32_32x32x16_bf16 v[56:71], v[24:27], v[16:19], v[108:123]
    v_exp_f32 v40, v40
    v_exp_f32 v41, v41
    v_exp_f32 v42, v42
    v_exp_f32 v43, v43
    v_mfma_f32_32x32x16_bf16 v[56:71], v[28:31], v[20:23], v[56:71]
    ds_read_b128 v[24:27], v128 offset:8192
    ds_read_b128 v[28:31], v128 offset:9216
    v_cvt_pk_bf16_f32 v72, v40, v41
    v_exp_f32 v44, v44
    v_exp_f32 v45, v45
    v_cvt_pk_bf16_f32 v73, v42, v43
    buffer_load_dwordx4 v[176:179], v131, s[8:11], s20 offen sc1
    s_waitcnt lgkmcnt(2)
    v_mfma_f32_32x32x16_bf16 v[88:103], v[32:35], v[80:83], v[88:103]
    v_exp_f32 v46, v46
    v_exp_f32 v47, v47
    v_cvt_pk_bf16_f32 v74, v44, v45
    v_exp_f32 v48, v48
    v_exp_f32 v49, v49
    v_cvt_pk_bf16_f32 v75, v46, v47
    v_exp_f32 v50, v50
    v_exp_f32 v51, v51
    buffer_load_dword v180, v208, s[8:11], s21 offen offset:0 sc1
    v_mfma_f32_32x32x16_bf16 v[88:103], v[36:39], v[84:87], v[88:103]
    ds_read_b128 v[32:35], v128 offset:2048
    ds_read_b128 v[36:39], v128 offset:3072
    v_cvt_pk_bf16_f32 v76, v48, v49
    v_exp_f32 v52, v52
    v_exp_f32 v53, v53
    v_cvt_pk_bf16_f32 v77, v50, v51
    v_smfmac_f32_16x16x64_bf16 v[104:107], v[124:127], v[80:87], v215
    v_exp_f32 v54, v54
    v_exp_f32 v55, v55
    v_cvt_pk_bf16_f32 v78, v52, v53
    v_cvt_pk_bf16_f32 v79, v54, v55
    buffer_load_dword v181, v208, s[8:11], s21 offen offset:256 sc1
    s_waitcnt lgkmcnt(2)
    v_mfma_f32_32x32x16_bf16 v[40:55], v[24:27], v[16:19], v[108:123]
    v_exp_f32 v56, v56
    v_exp_f32 v57, v57
    v_exp_f32 v58, v58
    v_exp_f32 v59, v59
    v_mfma_f32_32x32x16_bf16 v[40:55], v[28:31], v[20:23], v[40:55]
    ds_read_b128 v[24:27], v128 offset:12288
    ds_read_b128 v[28:31], v128 offset:13312
    v_cvt_pk_bf16_f32 v80, v56, v57
    v_exp_f32 v60, v60
    v_exp_f32 v61, v61
    v_cvt_pk_bf16_f32 v81, v58, v59
    buffer_load_dword v182, v208, s[8:11], s21 offen offset:512 sc1
    s_waitcnt lgkmcnt(2)
    v_mfma_f32_32x32x16_bf16 v[88:103], v[32:35], v[72:75], v[88:103]
    v_exp_f32 v62, v62
    v_exp_f32 v63, v63
    v_cvt_pk_bf16_f32 v82, v60, v61
    v_exp_f32 v64, v64
    v_exp_f32 v65, v65
    v_cvt_pk_bf16_f32 v83, v62, v63
    v_exp_f32 v66, v66
    v_exp_f32 v67, v67
    buffer_load_dword v183, v208, s[8:11], s21 offen offset:768 sc1
    v_mfma_f32_32x32x16_bf16 v[88:103], v[36:39], v[76:79], v[88:103]
    ds_read_b128 v[32:35], v128 offset:6144
    ds_read_b128 v[36:39], v128 offset:7168
    v_cvt_pk_bf16_f32 v84, v64, v65
    v_exp_f32 v68, v68
    v_exp_f32 v69, v69
    v_cvt_pk_bf16_f32 v85, v66, v67
    v_smfmac_f32_16x16x64_bf16 v[104:107], v[124:127], v[72:79], v215
    v_exp_f32 v70, v70
    v_exp_f32 v71, v71
    v_cvt_pk_bf16_f32 v86, v68, v69
    v_cvt_pk_bf16_f32 v87, v70, v71
    buffer_load_dword v184, v208, s[8:11], s21 offen offset:1024 sc1
    s_waitcnt vmcnt(20)
    s_barrier
    s_waitcnt lgkmcnt(2)
    v_mfma_f32_32x32x16_bf16 v[56:71], v[24:27], v[16:19], v[108:123]
    v_exp_f32 v40, v40
    v_exp_f32 v41, v41
    v_exp_f32 v42, v42
    v_exp_f32 v43, v43
    v_mfma_f32_32x32x16_bf16 v[56:71], v[28:31], v[20:23], v[56:71]
    ds_read_b128 v[24:27], v129 offset:0
    ds_read_b128 v[28:31], v129 offset:1024
    v_cvt_pk_bf16_f32 v72, v40, v41
    v_exp_f32 v44, v44
    v_exp_f32 v45, v45
    v_cvt_pk_bf16_f32 v73, v42, v43
    buffer_load_dword v185, v208, s[8:11], s21 offen offset:1280 sc1
    s_waitcnt lgkmcnt(2)
    v_mfma_f32_32x32x16_bf16 v[88:103], v[32:35], v[80:83], v[88:103]
    v_exp_f32 v46, v46
    v_exp_f32 v47, v47
    v_cvt_pk_bf16_f32 v74, v44, v45
    v_exp_f32 v48, v48
    s_add_u32 m0, s37, s39
    s_add_u32 s37, s37, 16384
    buffer_load_dwordx4 v130, s[8:11], s36 offen sc1 lds
    v_exp_f32 v49, v49
    v_cvt_pk_bf16_f32 v75, v46, v47
    v_exp_f32 v50, v50
    v_exp_f32 v51, v51
    buffer_load_dword v186, v208, s[8:11], s21 offen offset:1536 sc1
    v_mfma_f32_32x32x16_bf16 v[88:103], v[36:39], v[84:87], v[88:103]
    ds_read_b128 v[32:35], v128 offset:10240
    ds_read_b128 v[36:39], v128 offset:11264
    v_cvt_pk_bf16_f32 v76, v48, v49
    v_exp_f32 v52, v52
    v_exp_f32 v53, v53
    v_cvt_pk_bf16_f32 v77, v50, v51
    v_smfmac_f32_16x16x64_bf16 v[104:107], v[124:127], v[80:87], v215
    v_exp_f32 v54, v54
    v_exp_f32 v55, v55
    v_cvt_pk_bf16_f32 v78, v52, v53
    v_cvt_pk_bf16_f32 v79, v54, v55
    buffer_load_dword v187, v208, s[8:11], s21 offen offset:1792 sc1
    s_waitcnt lgkmcnt(2)
    v_mfma_f32_32x32x16_bf16 v[40:55], v[24:27], v[16:19], v[108:123]
    v_exp_f32 v56, v56
    v_exp_f32 v57, v57
    v_exp_f32 v58, v58
    v_exp_f32 v59, v59
    v_mfma_f32_32x32x16_bf16 v[40:55], v[28:31], v[20:23], v[40:55]
    ds_read_b128 v[24:27], v129 offset:4096
    ds_read_b128 v[28:31], v129 offset:5120
    v_cvt_pk_bf16_f32 v80, v56, v57
    v_exp_f32 v60, v60
    v_exp_f32 v61, v61
    v_cvt_pk_bf16_f32 v81, v58, v59
    s_waitcnt lgkmcnt(2)
    v_mfma_f32_32x32x16_bf16 v[88:103], v[32:35], v[72:75], v[88:103]
    v_exp_f32 v62, v62
    v_exp_f32 v63, v63
    v_cvt_pk_bf16_f32 v82, v60, v61
    v_exp_f32 v64, v64
    buffer_load_dwordx4 v130, s[8:11], s36 offen offset:1024 sc1 lds
    s_and_b32 s37, s37, 65535
    s_add_u32 s36, s36, 16384
    v_exp_f32 v65, v65
    v_cvt_pk_bf16_f32 v83, v62, v63
    v_exp_f32 v66, v66
    v_exp_f32 v67, v67
    v_mfma_f32_32x32x16_bf16 v[88:103], v[36:39], v[76:79], v[88:103]
    ds_read_b128 v[32:35], v128 offset:14336
    ds_read_b128 v[36:39], v128 offset:15360
    v_cvt_pk_bf16_f32 v84, v64, v65
    v_exp_f32 v68, v68
    v_exp_f32 v69, v69
    v_cvt_pk_bf16_f32 v85, v66, v67
    v_smfmac_f32_16x16x64_bf16 v[104:107], v[124:127], v[72:79], v215
    v_exp_f32 v70, v70
    v_exp_f32 v71, v71
    v_cvt_pk_bf16_f32 v86, v68, v69
    v_cvt_pk_bf16_f32 v87, v70, v71
    v_mov_b32 v128, v129
    v_add_u32 v129, 16384, v129
    v_and_b32 v129, 65535, v129
    s_waitcnt vmcnt(1)
    s_waitcnt lgkmcnt(2)
    v_mfma_f32_32x32x16_bf16 v[56:71], v[24:27], v[16:19], v[108:123]
    v_exp_f32 v40, v40
    v_exp_f32 v41, v41
    v_exp_f32 v42, v42
    v_exp_f32 v43, v43
    v_add_f32 v148, v148, v152
    v_add_f32 v149, v149, v153
    v_add_f32 v150, v150, v154
    v_add_f32 v151, v151, v155
    v_mfma_f32_32x32x16_bf16 v[56:71], v[28:31], v[20:23], v[56:71]
    ds_read_b128 v[24:27], v128 offset:8192
    ds_read_b128 v[28:31], v128 offset:9216
    v_cvt_pk_bf16_f32 v72, v40, v41
    v_exp_f32 v44, v44
    v_exp_f32 v45, v45
    v_cvt_pk_bf16_f32 v73, v42, v43
    v_add_f32 v156, v156, v160
    v_add_f32 v157, v157, v161
    v_add_f32 v158, v158, v162
    v_add_f32 v159, v159, v163
    v_add_f32 v164, v164, v168
    s_waitcnt lgkmcnt(2)
    v_mfma_f32_32x32x16_bf16 v[88:103], v[32:35], v[80:83], v[88:103]
    v_exp_f32 v46, v46
    v_exp_f32 v47, v47
    v_cvt_pk_bf16_f32 v74, v44, v45
    v_exp_f32 v48, v48
    v_add_f32 v165, v165, v169
    v_add_f32 v166, v166, v170
    v_add_f32 v167, v167, v171
    v_add_f32 v172, v172, v176
    v_add_f32 v173, v173, v177
    v_exp_f32 v49, v49
    v_cvt_pk_bf16_f32 v75, v46, v47
    v_exp_f32 v50, v50
    v_exp_f32 v51, v51
    v_add_f32 v174, v174, v178
    v_add_f32 v175, v175, v179
    v_add_f32 v148, v148, v156
    v_add_f32 v149, v149, v157
    v_mfma_f32_32x32x16_bf16 v[88:103], v[36:39], v[84:87], v[88:103]
    ds_read_b128 v[32:35], v128 offset:2048
    ds_read_b128 v[36:39], v128 offset:3072
    v_cvt_pk_bf16_f32 v76, v48, v49
    v_exp_f32 v52, v52
    v_exp_f32 v53, v53
    v_cvt_pk_bf16_f32 v77, v50, v51
    v_add_f32 v150, v150, v158
    v_add_f32 v151, v151, v159
    v_add_f32 v164, v164, v172
    v_add_f32 v165, v165, v173
    v_add_f32 v166, v166, v174
    v_smfmac_f32_16x16x64_bf16 v[104:107], v[124:127], v[80:87], v215
    v_exp_f32 v54, v54
    v_exp_f32 v55, v55
    v_cvt_pk_bf16_f32 v78, v52, v53
    v_cvt_pk_bf16_f32 v79, v54, v55
    v_add_f32 v167, v167, v175
    v_add_f32 v148, v148, v164
    v_add_f32 v149, v149, v165
    v_add_f32 v150, v150, v166
    v_add_f32 v151, v151, v167
    s_waitcnt lgkmcnt(2)
    v_mfma_f32_32x32x16_bf16 v[40:55], v[24:27], v[16:19], v[108:123]
    v_exp_f32 v56, v56
    v_exp_f32 v57, v57
    v_exp_f32 v58, v58
    v_exp_f32 v59, v59
    v_add_f32 v180, v180, v181
    v_add_f32 v182, v182, v183
    v_add_f32 v184, v184, v185
    v_mfma_f32_32x32x16_bf16 v[40:55], v[28:31], v[20:23], v[40:55]
    ds_read_b128 v[24:27], v128 offset:12288
    ds_read_b128 v[28:31], v128 offset:13312
    v_cvt_pk_bf16_f32 v80, v56, v57
    v_exp_f32 v60, v60
    v_exp_f32 v61, v61
    v_cvt_pk_bf16_f32 v81, v58, v59
    v_add_f32 v186, v186, v187
    v_add_f32 v180, v180, v182
    v_add_f32 v184, v184, v186
    s_waitcnt lgkmcnt(2)
    v_mfma_f32_32x32x16_bf16 v[88:103], v[32:35], v[72:75], v[88:103]
    v_exp_f32 v62, v62
    v_exp_f32 v63, v63
    v_cvt_pk_bf16_f32 v82, v60, v61
    v_exp_f32 v64, v64
    v_cvt_pk_bf16_f32 v148, v148, v149
    v_cvt_pk_bf16_f32 v149, v150, v151
    v_add_f32 v180, v180, v184
    v_cvt_pk_bf16_f32 v180, v180, v180
    ds_write_b64 v209, v[148:149]
    ds_write_b16 v210, v180
    v_exp_f32 v65, v65
    v_cvt_pk_bf16_f32 v83, v62, v63
    v_exp_f32 v66, v66
    v_exp_f32 v67, v67
    v_mfma_f32_32x32x16_bf16 v[88:103], v[36:39], v[76:79], v[88:103]
    ds_read_b128 v[32:35], v128 offset:6144
    ds_read_b128 v[36:39], v128 offset:7168
    v_cvt_pk_bf16_f32 v84, v64, v65
    v_exp_f32 v68, v68
    v_exp_f32 v69, v69
    v_cvt_pk_bf16_f32 v85, v66, v67
    v_smfmac_f32_16x16x64_bf16 v[104:107], v[124:127], v[72:79], v215
    v_exp_f32 v70, v70
    v_exp_f32 v71, v71
    v_cvt_pk_bf16_f32 v86, v68, v69
    v_cvt_pk_bf16_f32 v87, v70, v71
    s_waitcnt lgkmcnt(2)
    s_barrier
    v_mfma_f32_32x32x16_bf16 v[56:71], v[24:27], v[16:19], v[108:123]
    v_exp_f32 v40, v40
    v_exp_f32 v41, v41
    v_exp_f32 v42, v42
    v_exp_f32 v43, v43
    v_mfma_f32_32x32x16_bf16 v[56:71], v[28:31], v[20:23], v[56:71]
    ds_read_b128 v[24:27], v129 offset:0
    ds_read_b128 v[28:31], v129 offset:1024
    v_cvt_pk_bf16_f32 v72, v40, v41
    v_exp_f32 v44, v44
    v_exp_f32 v45, v45
    v_cvt_pk_bf16_f32 v73, v42, v43
    s_waitcnt lgkmcnt(2)
    v_mfma_f32_32x32x16_bf16 v[88:103], v[32:35], v[80:83], v[88:103]
    v_exp_f32 v46, v46
    v_exp_f32 v47, v47
    v_cvt_pk_bf16_f32 v74, v44, v45
    v_exp_f32 v48, v48
    s_add_u32 m0, s37, s39
    s_add_u32 s37, s37, 16384
    buffer_load_dwordx4 v130, s[8:11], s36 offen sc1 lds
    ds_read_b128 v[148:151], v212 offset:0
    ds_read_b128 v[152:155], v212 offset:1024
    ds_read_b128 v[156:159], v212 offset:2048
    ds_read_b128 v[160:163], v212 offset:3072
    v_exp_f32 v49, v49
    v_cvt_pk_bf16_f32 v75, v46, v47
    v_exp_f32 v50, v50
    v_exp_f32 v51, v51
    v_mfma_f32_32x32x16_bf16 v[88:103], v[36:39], v[84:87], v[88:103]
    ds_read_b128 v[32:35], v128 offset:10240
    ds_read_b128 v[36:39], v128 offset:11264
    v_cvt_pk_bf16_f32 v76, v48, v49
    v_exp_f32 v52, v52
    v_exp_f32 v53, v53
    v_cvt_pk_bf16_f32 v77, v50, v51
    v_smfmac_f32_16x16x64_bf16 v[104:107], v[124:127], v[80:87], v215
    v_exp_f32 v54, v54
    v_exp_f32 v55, v55
    v_cvt_pk_bf16_f32 v78, v52, v53
    v_cvt_pk_bf16_f32 v79, v54, v55
    s_waitcnt lgkmcnt(6)
    v_mfma_f32_32x32x16_bf16 v[40:55], v[24:27], v[16:19], v[108:123]
    v_exp_f32 v56, v56
    v_exp_f32 v57, v57
    v_exp_f32 v58, v58
    v_exp_f32 v59, v59
    v_mfma_f32_32x32x16_bf16 v[40:55], v[28:31], v[20:23], v[40:55]
    ds_read_b128 v[24:27], v129 offset:4096
    ds_read_b128 v[28:31], v129 offset:5120
    v_cvt_pk_bf16_f32 v80, v56, v57
    v_exp_f32 v60, v60
    v_exp_f32 v61, v61
    v_cvt_pk_bf16_f32 v81, v58, v59
    s_waitcnt lgkmcnt(2)
    v_mfma_f32_32x32x16_bf16 v[88:103], v[32:35], v[72:75], v[88:103]
    v_exp_f32 v62, v62
    v_exp_f32 v63, v63
    v_cvt_pk_bf16_f32 v82, v60, v61
    v_exp_f32 v64, v64
    buffer_load_dwordx4 v130, s[8:11], s36 offen offset:1024 sc1 lds
    s_and_b32 s37, s37, 65535
    s_add_u32 s36, s36, 16384
    ds_read_b64 v[164:165], v211 offset:0
    ds_read_b64 v[166:167], v211 offset:16
    ds_read_b64 v[168:169], v211 offset:32
    ds_read_b64 v[170:171], v211 offset:48
    ds_read_b64 v[172:173], v211 offset:64
    ds_read_b64 v[174:175], v211 offset:80
    ds_read_b64 v[176:177], v211 offset:96
    ds_read_b64 v[178:179], v211 offset:112
    buffer_load_dword v10, v11, s[52:55], s26 offen
    s_add_u32 s26, s26, 2048
    v_exp_f32 v65, v65
    v_cvt_pk_bf16_f32 v83, v62, v63
    v_exp_f32 v66, v66
    v_exp_f32 v67, v67
    v_mfma_f32_32x32x16_bf16 v[88:103], v[36:39], v[76:79], v[88:103]
    ds_read_b128 v[32:35], v128 offset:14336
    ds_read_b128 v[36:39], v128 offset:15360
    v_cvt_pk_bf16_f32 v84, v64, v65
    v_exp_f32 v68, v68
    v_exp_f32 v69, v69
    v_cvt_pk_bf16_f32 v85, v66, v67
    v_smfmac_f32_16x16x64_bf16 v[104:107], v[124:127], v[72:79], v215
    v_exp_f32 v70, v70
    v_exp_f32 v71, v71
    v_cvt_pk_bf16_f32 v86, v68, v69
    v_cvt_pk_bf16_f32 v87, v70, v71
    v_mov_b32 v128, v129
    v_add_u32 v129, 16384, v129
    v_and_b32 v129, 65535, v129
    s_waitcnt lgkmcnt(10)
    v_mfma_f32_32x32x16_bf16 v[56:71], v[24:27], v[16:19], v[108:123]
    v_exp_f32 v40, v40
    v_exp_f32 v41, v41
    v_exp_f32 v42, v42
    v_exp_f32 v43, v43
    v_mfma_f32_32x32x16_bf16 v[56:71], v[28:31], v[20:23], v[56:71]
    ds_read_b128 v[24:27], v128 offset:8192
    ds_read_b128 v[28:31], v128 offset:9216
    v_cvt_pk_bf16_f32 v72, v40, v41
    v_exp_f32 v44, v44
    v_exp_f32 v45, v45
    v_cvt_pk_bf16_f32 v73, v42, v43
    s_waitcnt lgkmcnt(2)
    v_mfma_f32_32x32x16_bf16 v[88:103], v[32:35], v[80:83], v[88:103]
    v_exp_f32 v46, v46
    v_exp_f32 v47, v47
    v_cvt_pk_bf16_f32 v74, v44, v45
    v_exp_f32 v48, v48
    v_mfma_f32_32x32x16_bf16 v[188:203], v[148:151], v[132:135], 0
    v_exp_f32 v49, v49
    v_cvt_pk_bf16_f32 v75, v46, v47
    v_exp_f32 v50, v50
    v_exp_f32 v51, v51
    v_mfma_f32_32x32x16_bf16 v[188:203], v[152:155], v[136:139], v[188:203]
    v_mfma_f32_32x32x16_bf16 v[88:103], v[36:39], v[84:87], v[88:103]
    ds_read_b128 v[32:35], v128 offset:2048
    ds_read_b128 v[36:39], v128 offset:3072
    v_cvt_pk_bf16_f32 v76, v48, v49
    v_exp_f32 v52, v52
    v_exp_f32 v53, v53
    v_cvt_pk_bf16_f32 v77, v50, v51
    v_mfma_f32_32x32x16_bf16 v[188:203], v[156:159], v[140:143], v[188:203]
    v_smfmac_f32_16x16x64_bf16 v[104:107], v[124:127], v[80:87], v215
    v_exp_f32 v54, v54
    v_exp_f32 v55, v55
    v_cvt_pk_bf16_f32 v78, v52, v53
    v_cvt_pk_bf16_f32 v79, v54, v55
    v_mfma_f32_32x32x16_bf16 v[188:203], v[160:163], v[144:147], v[188:203]
    s_waitcnt lgkmcnt(2)
    v_mfma_f32_32x32x16_bf16 v[40:55], v[24:27], v[16:19], v[108:123]
    v_exp_f32 v56, v56
    v_exp_f32 v57, v57
    v_exp_f32 v58, v58
    v_exp_f32 v59, v59
    v_mfma_f32_32x32x16_bf16 v[40:55], v[28:31], v[20:23], v[40:55]
    ds_read_b128 v[24:27], v128 offset:12288
    ds_read_b128 v[28:31], v128 offset:13312
    v_cvt_pk_bf16_f32 v80, v56, v57
    v_exp_f32 v60, v60
    v_exp_f32 v61, v61
    v_cvt_pk_bf16_f32 v81, v58, v59
    s_waitcnt lgkmcnt(2)
    v_mfma_f32_32x32x16_bf16 v[88:103], v[32:35], v[72:75], v[88:103]
    v_exp_f32 v62, v62
    v_exp_f32 v63, v63
    v_cvt_pk_bf16_f32 v82, v60, v61
    v_exp_f32 v64, v64
    v_mfma_f32_16x16x32_bf16 v[204:207], v[164:167], v[132:135], 0
    v_mfma_f32_16x16x32_bf16 v[204:207], v[168:171], v[136:139], v[204:207]
    v_mfma_f32_16x16x32_bf16 v[204:207], v[172:175], v[140:143], v[204:207]
    v_mfma_f32_16x16x32_bf16 v[204:207], v[176:179], v[144:147], v[204:207]
    buffer_load_dword v10, v11, s[52:55], s26 offen
    s_add_u32 s26, s26, 2048
    v_exp_f32 v65, v65
    v_cvt_pk_bf16_f32 v83, v62, v63
    v_exp_f32 v66, v66
    v_exp_f32 v67, v67
    v_mfma_f32_32x32x16_bf16 v[88:103], v[36:39], v[76:79], v[88:103]
    ds_read_b128 v[32:35], v128 offset:6144
    ds_read_b128 v[36:39], v128 offset:7168
    v_cvt_pk_bf16_f32 v84, v64, v65
    v_exp_f32 v68, v68
    v_exp_f32 v69, v69
    v_cvt_pk_bf16_f32 v85, v66, v67
    v_smfmac_f32_16x16x64_bf16 v[104:107], v[124:127], v[72:79], v215
    v_exp_f32 v70, v70
    v_exp_f32 v71, v71
    v_cvt_pk_bf16_f32 v86, v68, v69
    v_cvt_pk_bf16_f32 v87, v70, v71
    s_waitcnt vmcnt(4)
    s_barrier
    s_waitcnt lgkmcnt(2)
    v_mfma_f32_32x32x16_bf16 v[56:71], v[24:27], v[16:19], v[108:123]
    v_exp_f32 v40, v40
    v_exp_f32 v41, v41
    v_exp_f32 v42, v42
    v_exp_f32 v43, v43
    v_add_f32 v204, 0x358637bd, v204
    v_rcp_f32 v204, v204
    s_nop 0
    v_mfma_f32_32x32x16_bf16 v[56:71], v[28:31], v[20:23], v[56:71]
    ds_read_b128 v[24:27], v129 offset:0
    ds_read_b128 v[28:31], v129 offset:1024
    v_cvt_pk_bf16_f32 v72, v40, v41
    v_exp_f32 v44, v44
    v_exp_f32 v45, v45
    v_cvt_pk_bf16_f32 v73, v42, v43
    v_mul_f32 v204, v204, v214
    v_mul_f32 v188, v188, v204
    v_mul_f32 v189, v189, v204
    s_waitcnt lgkmcnt(2)
    v_mfma_f32_32x32x16_bf16 v[88:103], v[32:35], v[80:83], v[88:103]
    v_exp_f32 v46, v46
    v_exp_f32 v47, v47
    v_cvt_pk_bf16_f32 v74, v44, v45
    v_exp_f32 v48, v48
    v_mul_f32 v190, v190, v204
    v_mul_f32 v191, v191, v204
    v_mul_f32 v192, v192, v204
    v_mul_f32 v193, v193, v204
    s_add_u32 m0, s37, s39
    s_add_u32 s37, s37, 16384
    buffer_load_dwordx4 v130, s[8:11], s36 offen sc1 lds
    v_exp_f32 v49, v49
    v_cvt_pk_bf16_f32 v75, v46, v47
    v_exp_f32 v50, v50
    v_exp_f32 v51, v51
    v_mul_f32 v194, v194, v204
    v_mul_f32 v195, v195, v204
    v_mul_f32 v196, v196, v204
    v_mfma_f32_32x32x16_bf16 v[88:103], v[36:39], v[84:87], v[88:103]
    ds_read_b128 v[32:35], v128 offset:10240
    ds_read_b128 v[36:39], v128 offset:11264
    v_cvt_pk_bf16_f32 v76, v48, v49
    v_exp_f32 v52, v52
    v_exp_f32 v53, v53
    v_cvt_pk_bf16_f32 v77, v50, v51
    v_mul_f32 v197, v197, v204
    v_mul_f32 v198, v198, v204
    v_mul_f32 v199, v199, v204
    v_smfmac_f32_16x16x64_bf16 v[104:107], v[124:127], v[80:87], v215
    v_exp_f32 v54, v54
    v_exp_f32 v55, v55
    v_cvt_pk_bf16_f32 v78, v52, v53
    v_cvt_pk_bf16_f32 v79, v54, v55
    v_mul_f32 v200, v200, v204
    v_mul_f32 v201, v201, v204
    v_mul_f32 v202, v202, v204
    v_mul_f32 v203, v203, v204
    s_waitcnt lgkmcnt(2)
    v_mfma_f32_32x32x16_bf16 v[40:55], v[24:27], v[16:19], v[108:123]
    v_exp_f32 v56, v56
    v_exp_f32 v57, v57
    v_exp_f32 v58, v58
    v_exp_f32 v59, v59
    v_cvt_pk_bf16_f32 v188, v188, v189
    v_mfma_f32_32x32x16_bf16 v[40:55], v[28:31], v[20:23], v[40:55]
    ds_read_b128 v[24:27], v129 offset:4096
    ds_read_b128 v[28:31], v129 offset:5120
    v_cvt_pk_bf16_f32 v80, v56, v57
    v_exp_f32 v60, v60
    v_exp_f32 v61, v61
    v_cvt_pk_bf16_f32 v81, v58, v59
    v_cvt_pk_bf16_f32 v189, v190, v191
    s_waitcnt lgkmcnt(2)
    v_mfma_f32_32x32x16_bf16 v[88:103], v[32:35], v[72:75], v[88:103]
    v_exp_f32 v62, v62
    v_exp_f32 v63, v63
    v_cvt_pk_bf16_f32 v82, v60, v61
    v_exp_f32 v64, v64
    v_cvt_pk_bf16_f32 v190, v192, v193
    v_cvt_pk_bf16_f32 v191, v194, v195
    buffer_load_dwordx4 v130, s[8:11], s36 offen offset:1024 sc1 lds
    s_and_b32 s37, s37, 65535
    s_add_u32 s36, s36, 16384
    buffer_load_dword v10, v11, s[52:55], s26 offen
    s_add_u32 s26, s26, 2048
    v_exp_f32 v65, v65
    v_cvt_pk_bf16_f32 v83, v62, v63
    v_exp_f32 v66, v66
    v_exp_f32 v67, v67
    v_cvt_pk_bf16_f32 v192, v196, v197
    v_mfma_f32_32x32x16_bf16 v[88:103], v[36:39], v[76:79], v[88:103]
    ds_read_b128 v[32:35], v128 offset:14336
    ds_read_b128 v[36:39], v128 offset:15360
    v_cvt_pk_bf16_f32 v84, v64, v65
    v_exp_f32 v68, v68
    v_exp_f32 v69, v69
    v_cvt_pk_bf16_f32 v85, v66, v67
    v_cvt_pk_bf16_f32 v193, v198, v199
    v_smfmac_f32_16x16x64_bf16 v[104:107], v[124:127], v[72:79], v215
    v_exp_f32 v70, v70
    v_exp_f32 v71, v71
    v_cvt_pk_bf16_f32 v86, v68, v69
    v_cvt_pk_bf16_f32 v87, v70, v71
    v_cvt_pk_bf16_f32 v194, v200, v201
    v_cvt_pk_bf16_f32 v195, v202, v203
    v_mov_b32 v128, v129
    v_add_u32 v129, 16384, v129
    v_and_b32 v129, 65535, v129
    s_waitcnt lgkmcnt(2)
    v_mfma_f32_32x32x16_bf16 v[56:71], v[24:27], v[16:19], v[108:123]
    v_exp_f32 v40, v40
    v_exp_f32 v41, v41
    v_exp_f32 v42, v42
    v_exp_f32 v43, v43
    v_mfma_f32_32x32x16_bf16 v[56:71], v[28:31], v[20:23], v[56:71]
    ds_read_b128 v[24:27], v128 offset:8192
    ds_read_b128 v[28:31], v128 offset:9216
    v_cvt_pk_bf16_f32 v72, v40, v41
    v_exp_f32 v44, v44
    v_exp_f32 v45, v45
    v_cvt_pk_bf16_f32 v73, v42, v43
    s_waitcnt lgkmcnt(2)
    v_mfma_f32_32x32x16_bf16 v[88:103], v[32:35], v[80:83], v[88:103]
    v_exp_f32 v46, v46
    v_exp_f32 v47, v47
    v_cvt_pk_bf16_f32 v74, v44, v45
    v_exp_f32 v48, v48
    buffer_store_dwordx4 v[188:191], v131, s[8:11], s23 offen offset:0 sc1
    buffer_store_dwordx4 v[192:195], v131, s[8:11], s23 offen offset:1024 sc1
    v_exp_f32 v49, v49
    v_cvt_pk_bf16_f32 v75, v46, v47
    v_exp_f32 v50, v50
    v_exp_f32 v51, v51
    v_mfma_f32_32x32x16_bf16 v[88:103], v[36:39], v[84:87], v[88:103]
    ds_read_b128 v[32:35], v128 offset:2048
    ds_read_b128 v[36:39], v128 offset:3072
    v_cvt_pk_bf16_f32 v76, v48, v49
    v_exp_f32 v52, v52
    v_exp_f32 v53, v53
    v_cvt_pk_bf16_f32 v77, v50, v51
    v_smfmac_f32_16x16x64_bf16 v[104:107], v[124:127], v[80:87], v215
    v_exp_f32 v54, v54
    v_exp_f32 v55, v55
    v_cvt_pk_bf16_f32 v78, v52, v53
    v_cvt_pk_bf16_f32 v79, v54, v55
    s_waitcnt lgkmcnt(2)
    v_mfma_f32_32x32x16_bf16 v[40:55], v[24:27], v[16:19], v[108:123]
    v_exp_f32 v56, v56
    v_exp_f32 v57, v57
    v_exp_f32 v58, v58
    v_exp_f32 v59, v59
    v_mfma_f32_32x32x16_bf16 v[40:55], v[28:31], v[20:23], v[40:55]
    ds_read_b128 v[24:27], v128 offset:12288
    ds_read_b128 v[28:31], v128 offset:13312
    v_cvt_pk_bf16_f32 v80, v56, v57
    v_exp_f32 v60, v60
    v_exp_f32 v61, v61
    v_cvt_pk_bf16_f32 v81, v58, v59
    s_waitcnt lgkmcnt(2)
    v_mfma_f32_32x32x16_bf16 v[88:103], v[32:35], v[72:75], v[88:103]
    v_exp_f32 v62, v62
    v_exp_f32 v63, v63
    v_cvt_pk_bf16_f32 v82, v60, v61
    v_exp_f32 v64, v64
    buffer_load_dword v10, v11, s[52:55], s26 offen
    s_add_u32 s26, s26, 2048
    v_exp_f32 v65, v65
    v_cvt_pk_bf16_f32 v83, v62, v63
    v_exp_f32 v66, v66
    v_exp_f32 v67, v67
    v_mfma_f32_32x32x16_bf16 v[88:103], v[36:39], v[76:79], v[88:103]
    ds_read_b128 v[32:35], v128 offset:6144
    ds_read_b128 v[36:39], v128 offset:7168
    v_cvt_pk_bf16_f32 v84, v64, v65
    v_exp_f32 v68, v68
    v_exp_f32 v69, v69
    v_cvt_pk_bf16_f32 v85, v66, v67
    v_smfmac_f32_16x16x64_bf16 v[104:107], v[124:127], v[72:79], v215
    v_exp_f32 v70, v70
    v_exp_f32 v71, v71
    v_cvt_pk_bf16_f32 v86, v68, v69
    v_cvt_pk_bf16_f32 v87, v70, v71
    s_waitcnt vmcnt(8)
    s_barrier
    s_waitcnt lgkmcnt(2)
    v_mfma_f32_32x32x16_bf16 v[56:71], v[24:27], v[16:19], v[108:123]
    v_exp_f32 v40, v40
    v_exp_f32 v41, v41
    v_exp_f32 v42, v42
    v_exp_f32 v43, v43
    v_mfma_f32_32x32x16_bf16 v[56:71], v[28:31], v[20:23], v[56:71]
    ds_read_b128 v[24:27], v129 offset:0
    ds_read_b128 v[28:31], v129 offset:1024
    v_cvt_pk_bf16_f32 v72, v40, v41
    v_exp_f32 v44, v44
    v_exp_f32 v45, v45
    v_cvt_pk_bf16_f32 v73, v42, v43
    s_waitcnt lgkmcnt(2)
    v_mfma_f32_32x32x16_bf16 v[88:103], v[32:35], v[80:83], v[88:103]
    v_exp_f32 v46, v46
    v_exp_f32 v47, v47
    v_cvt_pk_bf16_f32 v74, v44, v45
    v_exp_f32 v48, v48
    s_add_u32 m0, s37, s39
    s_add_u32 s37, s37, 16384
    buffer_load_dwordx4 v130, s[8:11], s36 offen sc1 lds
    v_exp_f32 v49, v49
    v_cvt_pk_bf16_f32 v75, v46, v47
    v_exp_f32 v50, v50
    v_exp_f32 v51, v51
    v_mfma_f32_32x32x16_bf16 v[88:103], v[36:39], v[84:87], v[88:103]
    ds_read_b128 v[32:35], v128 offset:10240
    ds_read_b128 v[36:39], v128 offset:11264
    v_cvt_pk_bf16_f32 v76, v48, v49
    v_exp_f32 v52, v52
    v_exp_f32 v53, v53
    v_cvt_pk_bf16_f32 v77, v50, v51
    v_smfmac_f32_16x16x64_bf16 v[104:107], v[124:127], v[80:87], v215
    v_exp_f32 v54, v54
    v_exp_f32 v55, v55
    v_cvt_pk_bf16_f32 v78, v52, v53
    v_cvt_pk_bf16_f32 v79, v54, v55
    s_waitcnt lgkmcnt(2)
    v_mfma_f32_32x32x16_bf16 v[40:55], v[24:27], v[16:19], v[108:123]
    v_exp_f32 v56, v56
    v_exp_f32 v57, v57
    v_exp_f32 v58, v58
    v_exp_f32 v59, v59
    v_mfma_f32_32x32x16_bf16 v[40:55], v[28:31], v[20:23], v[40:55]
    ds_read_b128 v[24:27], v129 offset:4096
    ds_read_b128 v[28:31], v129 offset:5120
    v_cvt_pk_bf16_f32 v80, v56, v57
    v_exp_f32 v60, v60
    v_exp_f32 v61, v61
    v_cvt_pk_bf16_f32 v81, v58, v59
    s_waitcnt lgkmcnt(2)
    v_mfma_f32_32x32x16_bf16 v[88:103], v[32:35], v[72:75], v[88:103]
    v_exp_f32 v62, v62
    v_exp_f32 v63, v63
    v_cvt_pk_bf16_f32 v82, v60, v61
    v_exp_f32 v64, v64
    buffer_load_dwordx4 v130, s[8:11], s36 offen offset:1024 sc1 lds
    s_and_b32 s37, s37, 65535
    s_add_u32 s36, s36, 16384
    buffer_load_dword v10, v11, s[52:55], s26 offen
    s_add_u32 s26, s26, 2048
    v_exp_f32 v65, v65
    v_cvt_pk_bf16_f32 v83, v62, v63
    v_exp_f32 v66, v66
    v_exp_f32 v67, v67
    v_mfma_f32_32x32x16_bf16 v[88:103], v[36:39], v[76:79], v[88:103]
    ds_read_b128 v[32:35], v128 offset:14336
    ds_read_b128 v[36:39], v128 offset:15360
    v_cvt_pk_bf16_f32 v84, v64, v65
    v_exp_f32 v68, v68
    v_exp_f32 v69, v69
    v_cvt_pk_bf16_f32 v85, v66, v67
    v_smfmac_f32_16x16x64_bf16 v[104:107], v[124:127], v[72:79], v215
    v_exp_f32 v70, v70
    v_exp_f32 v71, v71
    v_cvt_pk_bf16_f32 v86, v68, v69
    v_cvt_pk_bf16_f32 v87, v70, v71
    v_mov_b32 v128, v129
    v_add_u32 v129, 16384, v129
    v_and_b32 v129, 65535, v129
    s_waitcnt lgkmcnt(2)
    v_mfma_f32_32x32x16_bf16 v[56:71], v[24:27], v[16:19], v[108:123]
    v_exp_f32 v40, v40
    v_exp_f32 v41, v41
    v_exp_f32 v42, v42
    v_exp_f32 v43, v43
    v_mfma_f32_32x32x16_bf16 v[56:71], v[28:31], v[20:23], v[56:71]
    ds_read_b128 v[24:27], v128 offset:8192
    ds_read_b128 v[28:31], v128 offset:9216
    v_cvt_pk_bf16_f32 v72, v40, v41
    v_exp_f32 v44, v44
    v_exp_f32 v45, v45
    v_cvt_pk_bf16_f32 v73, v42, v43
    s_waitcnt lgkmcnt(2)
    v_mfma_f32_32x32x16_bf16 v[88:103], v[32:35], v[80:83], v[88:103]
    v_exp_f32 v46, v46
    v_exp_f32 v47, v47
    v_cvt_pk_bf16_f32 v74, v44, v45
    v_exp_f32 v48, v48
    v_exp_f32 v49, v49
    v_cvt_pk_bf16_f32 v75, v46, v47
    v_exp_f32 v50, v50
    v_exp_f32 v51, v51
    v_mfma_f32_32x32x16_bf16 v[88:103], v[36:39], v[84:87], v[88:103]
    ds_read_b128 v[32:35], v128 offset:2048
    ds_read_b128 v[36:39], v128 offset:3072
    v_cvt_pk_bf16_f32 v76, v48, v49
    v_exp_f32 v52, v52
    v_exp_f32 v53, v53
    v_cvt_pk_bf16_f32 v77, v50, v51
    v_smfmac_f32_16x16x64_bf16 v[104:107], v[124:127], v[80:87], v215
    v_exp_f32 v54, v54
    v_exp_f32 v55, v55
    v_cvt_pk_bf16_f32 v78, v52, v53
    v_cvt_pk_bf16_f32 v79, v54, v55
    s_waitcnt lgkmcnt(2)
    v_mfma_f32_32x32x16_bf16 v[40:55], v[24:27], v[16:19], v[108:123]
    v_exp_f32 v56, v56
    v_exp_f32 v57, v57
    v_exp_f32 v58, v58
    v_exp_f32 v59, v59
    v_mfma_f32_32x32x16_bf16 v[40:55], v[28:31], v[20:23], v[40:55]
    ds_read_b128 v[24:27], v128 offset:12288
    ds_read_b128 v[28:31], v128 offset:13312
    v_cvt_pk_bf16_f32 v80, v56, v57
    v_exp_f32 v60, v60
    v_exp_f32 v61, v61
    v_cvt_pk_bf16_f32 v81, v58, v59
    s_waitcnt lgkmcnt(2)
    v_mfma_f32_32x32x16_bf16 v[88:103], v[32:35], v[72:75], v[88:103]
    v_exp_f32 v62, v62
    v_exp_f32 v63, v63
    v_cvt_pk_bf16_f32 v82, v60, v61
    v_exp_f32 v64, v64
    buffer_load_dword v10, v11, s[52:55], s26 offen
    s_add_u32 s26, s26, 2048
    v_exp_f32 v65, v65
    v_cvt_pk_bf16_f32 v83, v62, v63
    v_exp_f32 v66, v66
    v_exp_f32 v67, v67
    v_mfma_f32_32x32x16_bf16 v[88:103], v[36:39], v[76:79], v[88:103]
    ds_read_b128 v[32:35], v128 offset:6144
    ds_read_b128 v[36:39], v128 offset:7168
    v_cvt_pk_bf16_f32 v84, v64, v65
    v_exp_f32 v68, v68
    v_exp_f32 v69, v69
    v_cvt_pk_bf16_f32 v85, v66, v67
    v_smfmac_f32_16x16x64_bf16 v[104:107], v[124:127], v[72:79], v215
    v_exp_f32 v70, v70
    v_exp_f32 v71, v71
    v_cvt_pk_bf16_f32 v86, v68, v69
    v_cvt_pk_bf16_f32 v87, v70, v71
    s_waitcnt vmcnt(8)
    s_waitcnt vmcnt(5)
    s_barrier
    s_cmp_lg_u32 s32, 0
    s_cbranch_scc1 M_NA
    s_mov_b32 s47, 24117248
    s_mov_b32 exec_hi, 0
    buffer_store_dword v221, v218, s[8:11], s47 offen offset:128 sc1
    s_mov_b32 exec_hi, -1
M_NA:
    s_waitcnt lgkmcnt(2)
    v_mfma_f32_32x32x16_bf16 v[56:71], v[24:27], v[16:19], v[108:123]
    v_exp_f32 v40, v40
    v_exp_f32 v41, v41
    v_exp_f32 v42, v42
    v_exp_f32 v43, v43
    v_mfma_f32_32x32x16_bf16 v[56:71], v[28:31], v[20:23], v[56:71]
    ds_read_b128 v[24:27], v129 offset:0
    ds_read_b128 v[28:31], v129 offset:1024
    v_cvt_pk_bf16_f32 v72, v40, v41
    v_exp_f32 v44, v44
    v_exp_f32 v45, v45
    v_cvt_pk_bf16_f32 v73, v42, v43
    s_waitcnt lgkmcnt(2)
    v_mfma_f32_32x32x16_bf16 v[88:103], v[32:35], v[80:83], v[88:103]
    v_exp_f32 v46, v46
    v_exp_f32 v47, v47
    v_cvt_pk_bf16_f32 v74, v44, v45
    v_exp_f32 v48, v48
    s_add_u32 m0, s37, s39
    s_add_u32 s37, s37, 16384
    buffer_load_dwordx4 v130, s[8:11], s36 offen sc1 lds
    v_exp_f32 v49, v49
    v_cvt_pk_bf16_f32 v75, v46, v47
    v_exp_f32 v50, v50
    v_exp_f32 v51, v51
    v_mfma_f32_32x32x16_bf16 v[88:103], v[36:39], v[84:87], v[88:103]
    ds_read_b128 v[32:35], v128 offset:10240
    ds_read_b128 v[36:39], v128 offset:11264
    v_cvt_pk_bf16_f32 v76, v48, v49
    v_exp_f32 v52, v52
    v_exp_f32 v53, v53
    v_cvt_pk_bf16_f32 v77, v50, v51
    v_smfmac_f32_16x16x64_bf16 v[104:107], v[124:127], v[80:87], v215
    v_exp_f32 v54, v54
    v_exp_f32 v55, v55
    v_cvt_pk_bf16_f32 v78, v52, v53
    v_cvt_pk_bf16_f32 v79, v54, v55
    s_waitcnt lgkmcnt(2)
    v_mfma_f32_32x32x16_bf16 v[40:55], v[24:27], v[16:19], v[108:123]
    v_exp_f32 v56, v56
    v_exp_f32 v57, v57
    v_exp_f32 v58, v58
    v_exp_f32 v59, v59
    v_mfma_f32_32x32x16_bf16 v[40:55], v[28:31], v[20:23], v[40:55]
    ds_read_b128 v[24:27], v129 offset:4096
    ds_read_b128 v[28:31], v129 offset:5120
    v_cvt_pk_bf16_f32 v80, v56, v57
    v_exp_f32 v60, v60
    v_exp_f32 v61, v61
    v_cvt_pk_bf16_f32 v81, v58, v59
    s_waitcnt lgkmcnt(2)
    v_mfma_f32_32x32x16_bf16 v[88:103], v[32:35], v[72:75], v[88:103]
    v_exp_f32 v62, v62
    v_exp_f32 v63, v63
    v_cvt_pk_bf16_f32 v82, v60, v61
    v_exp_f32 v64, v64
    buffer_load_dwordx4 v130, s[8:11], s36 offen offset:1024 sc1 lds
    s_and_b32 s37, s37, 65535
    s_add_u32 s36, s36, 16384
    buffer_load_dword v10, v11, s[52:55], s26 offen
    s_add_u32 s26, s26, 2048
    v_exp_f32 v65, v65
    v_cvt_pk_bf16_f32 v83, v62, v63
    v_exp_f32 v66, v66
    v_exp_f32 v67, v67
    v_mfma_f32_32x32x16_bf16 v[88:103], v[36:39], v[76:79], v[88:103]
    ds_read_b128 v[32:35], v128 offset:14336
    ds_read_b128 v[36:39], v128 offset:15360
    v_cvt_pk_bf16_f32 v84, v64, v65
    v_exp_f32 v68, v68
    v_exp_f32 v69, v69
    v_cvt_pk_bf16_f32 v85, v66, v67
    v_smfmac_f32_16x16x64_bf16 v[104:107], v[124:127], v[72:79], v215
    v_exp_f32 v70, v70
    v_exp_f32 v71, v71
    v_cvt_pk_bf16_f32 v86, v68, v69
    v_cvt_pk_bf16_f32 v87, v70, v71
    v_mov_b32 v128, v129
    v_add_u32 v129, 16384, v129
    v_and_b32 v129, 65535, v129
    s_waitcnt lgkmcnt(2)
    v_mfma_f32_32x32x16_bf16 v[56:71], v[24:27], v[16:19], v[108:123]
    v_exp_f32 v40, v40
    v_exp_f32 v41, v41
    v_exp_f32 v42, v42
    v_exp_f32 v43, v43
    v_mfma_f32_32x32x16_bf16 v[56:71], v[28:31], v[20:23], v[56:71]
    ds_read_b128 v[24:27], v128 offset:8192
    ds_read_b128 v[28:31], v128 offset:9216
    v_cvt_pk_bf16_f32 v72, v40, v41
    v_exp_f32 v44, v44
    v_exp_f32 v45, v45
    v_cvt_pk_bf16_f32 v73, v42, v43
    s_waitcnt lgkmcnt(2)
    v_mfma_f32_32x32x16_bf16 v[88:103], v[32:35], v[80:83], v[88:103]
    v_exp_f32 v46, v46
    v_exp_f32 v47, v47
    v_cvt_pk_bf16_f32 v74, v44, v45
    v_exp_f32 v48, v48
    v_exp_f32 v49, v49
    v_cvt_pk_bf16_f32 v75, v46, v47
    v_exp_f32 v50, v50
    v_exp_f32 v51, v51
    v_mfma_f32_32x32x16_bf16 v[88:103], v[36:39], v[84:87], v[88:103]
    ds_read_b128 v[32:35], v128 offset:2048
    ds_read_b128 v[36:39], v128 offset:3072
    v_cvt_pk_bf16_f32 v76, v48, v49
    v_exp_f32 v52, v52
    v_exp_f32 v53, v53
    v_cvt_pk_bf16_f32 v77, v50, v51
    v_smfmac_f32_16x16x64_bf16 v[104:107], v[124:127], v[80:87], v215
    v_exp_f32 v54, v54
    v_exp_f32 v55, v55
    v_cvt_pk_bf16_f32 v78, v52, v53
    v_cvt_pk_bf16_f32 v79, v54, v55
    s_waitcnt lgkmcnt(2)
    v_mfma_f32_32x32x16_bf16 v[40:55], v[24:27], v[16:19], v[108:123]
    v_exp_f32 v56, v56
    v_exp_f32 v57, v57
    v_exp_f32 v58, v58
    v_exp_f32 v59, v59
    v_mfma_f32_32x32x16_bf16 v[40:55], v[28:31], v[20:23], v[40:55]
    ds_read_b128 v[24:27], v128 offset:12288
    ds_read_b128 v[28:31], v128 offset:13312
    v_cvt_pk_bf16_f32 v80, v56, v57
    v_exp_f32 v60, v60
    v_exp_f32 v61, v61
    v_cvt_pk_bf16_f32 v81, v58, v59
    s_waitcnt lgkmcnt(2)
    v_mfma_f32_32x32x16_bf16 v[88:103], v[32:35], v[72:75], v[88:103]
    v_exp_f32 v62, v62
    v_exp_f32 v63, v63
    v_cvt_pk_bf16_f32 v82, v60, v61
    v_exp_f32 v64, v64
    buffer_load_dword v10, v11, s[52:55], s26 offen
    s_add_u32 s26, s26, 2048
    v_exp_f32 v65, v65
    v_cvt_pk_bf16_f32 v83, v62, v63
    v_exp_f32 v66, v66
    v_exp_f32 v67, v67
    v_mfma_f32_32x32x16_bf16 v[88:103], v[36:39], v[76:79], v[88:103]
    ds_read_b128 v[32:35], v128 offset:6144
    ds_read_b128 v[36:39], v128 offset:7168
    v_cvt_pk_bf16_f32 v84, v64, v65
    v_exp_f32 v68, v68
    v_exp_f32 v69, v69
    v_cvt_pk_bf16_f32 v85, v66, v67
    v_smfmac_f32_16x16x64_bf16 v[104:107], v[124:127], v[72:79], v215
    v_exp_f32 v70, v70
    v_exp_f32 v71, v71
    v_cvt_pk_bf16_f32 v86, v68, v69
    v_cvt_pk_bf16_f32 v87, v70, v71
    s_waitcnt vmcnt(6)
    s_barrier
    s_waitcnt lgkmcnt(2)
    v_mfma_f32_32x32x16_bf16 v[56:71], v[24:27], v[16:19], v[108:123]
    v_exp_f32 v40, v40
    v_exp_f32 v41, v41
    v_exp_f32 v42, v42
    v_exp_f32 v43, v43
    v_mfma_f32_32x32x16_bf16 v[56:71], v[28:31], v[20:23], v[56:71]
    ds_read_b128 v[24:27], v129 offset:0
    ds_read_b128 v[28:31], v129 offset:1024
    v_cvt_pk_bf16_f32 v72, v40, v41
    v_exp_f32 v44, v44
    v_exp_f32 v45, v45
    v_cvt_pk_bf16_f32 v73, v42, v43
    s_waitcnt lgkmcnt(2)
    v_mfma_f32_32x32x16_bf16 v[88:103], v[32:35], v[80:83], v[88:103]
    v_exp_f32 v46, v46
    v_exp_f32 v47, v47
    v_cvt_pk_bf16_f32 v74, v44, v45
    v_exp_f32 v48, v48
    s_add_u32 m0, s37, s39
    s_add_u32 s37, s37, 16384
    buffer_load_dwordx4 v130, s[8:11], s36 offen sc1 lds
    v_exp_f32 v49, v49
    v_cvt_pk_bf16_f32 v75, v46, v47
    v_exp_f32 v50, v50
    v_exp_f32 v51, v51
    v_mfma_f32_32x32x16_bf16 v[88:103], v[36:39], v[84:87], v[88:103]
    ds_read_b128 v[32:35], v128 offset:10240
    ds_read_b128 v[36:39], v128 offset:11264
    v_cvt_pk_bf16_f32 v76, v48, v49
    v_exp_f32 v52, v52
    v_exp_f32 v53, v53
    v_cvt_pk_bf16_f32 v77, v50, v51
    v_smfmac_f32_16x16x64_bf16 v[104:107], v[124:127], v[80:87], v215
    v_exp_f32 v54, v54
    v_exp_f32 v55, v55
    v_cvt_pk_bf16_f32 v78, v52, v53
    v_cvt_pk_bf16_f32 v79, v54, v55
    s_waitcnt lgkmcnt(2)
    v_mfma_f32_32x32x16_bf16 v[40:55], v[24:27], v[16:19], v[108:123]
    v_exp_f32 v56, v56
    v_exp_f32 v57, v57
    v_exp_f32 v58, v58
    v_exp_f32 v59, v59
    v_mfma_f32_32x32x16_bf16 v[40:55], v[28:31], v[20:23], v[40:55]
    ds_read_b128 v[24:27], v129 offset:4096
    ds_read_b128 v[28:31], v129 offset:5120
    v_cvt_pk_bf16_f32 v80, v56, v57
    v_exp_f32 v60, v60
    v_exp_f32 v61, v61
    v_cvt_pk_bf16_f32 v81, v58, v59
    s_waitcnt lgkmcnt(2)
    v_mfma_f32_32x32x16_bf16 v[88:103], v[32:35], v[72:75], v[88:103]
    v_exp_f32 v62, v62
    v_exp_f32 v63, v63
    v_cvt_pk_bf16_f32 v82, v60, v61
    v_exp_f32 v64, v64
    buffer_load_dwordx4 v130, s[8:11], s36 offen offset:1024 sc1 lds
    s_and_b32 s37, s37, 65535
    s_add_u32 s36, s36, 16384
    s_add_u32 m0, s28, 0
    s_mov_b32 s29, 0
    buffer_load_dwordx4 v216, s[12:15], s29 offen lds
    s_add_u32 m0, s28, 1024
    s_nop 0
    buffer_load_dwordx4 v217, s[12:15], s29 offen lds
    v_exp_f32 v65, v65
    v_cvt_pk_bf16_f32 v83, v62, v63
    v_exp_f32 v66, v66
    v_exp_f32 v67, v67
    v_mfma_f32_32x32x16_bf16 v[88:103], v[36:39], v[76:79], v[88:103]
    ds_read_b128 v[32:35], v128 offset:14336
    ds_read_b128 v[36:39], v128 offset:15360
    v_cvt_pk_bf16_f32 v84, v64, v65
    v_exp_f32 v68, v68
    v_exp_f32 v69, v69
    v_cvt_pk_bf16_f32 v85, v66, v67
    v_smfmac_f32_16x16x64_bf16 v[104:107], v[124:127], v[72:79], v215
    v_exp_f32 v70, v70
    v_exp_f32 v71, v71
    v_cvt_pk_bf16_f32 v86, v68, v69
    v_cvt_pk_bf16_f32 v87, v70, v71
    v_mov_b32 v128, v129
    v_add_u32 v129, 16384, v129
    v_and_b32 v129, 65535, v129
    s_mov_b32 s38, 1
.p2align 5
K2_LOOP:
    s_mov_b32 s38, 1
    s_mov_b32 s37, s37
    s_sub_u32 s38, s38, 1
    s_cmp_lg_u32 s38, 0
    s_cbranch_scc1 K2_LOOP
    s_waitcnt lgkmcnt(2)
    v_mfma_f32_32x32x16_bf16 v[56:71], v[24:27], v[16:19], v[108:123]
    v_exp_f32 v40, v40
    v_exp_f32 v41, v41
    v_exp_f32 v42, v42
    v_exp_f32 v43, v43
    v_mfma_f32_32x32x16_bf16 v[56:71], v[28:31], v[20:23], v[56:71]
    ds_read_b128 v[24:27], v128 offset:8192
    ds_read_b128 v[28:31], v128 offset:9216
    v_cvt_pk_bf16_f32 v72, v40, v41
    v_exp_f32 v44, v44
    v_exp_f32 v45, v45
    v_cvt_pk_bf16_f32 v73, v42, v43
    s_waitcnt lgkmcnt(2)
    v_mfma_f32_32x32x16_bf16 v[88:103], v[32:35], v[80:83], v[88:103]
    v_exp_f32 v46, v46
    v_exp_f32 v47, v47
    v_cvt_pk_bf16_f32 v74, v44, v45
    v_exp_f32 v48, v48
    s_add_u32 m0, s28, 16384
    s_mov_b32 s29, 131072
    buffer_load_dwordx4 v216, s[12:15], s29 offen lds
    s_add_u32 m0, s28, 17408
    s_nop 0
    buffer_load_dwordx4 v217, s[12:15], s29 offen lds
    v_exp_f32 v49, v49
    v_cvt_pk_bf16_f32 v75, v46, v47
    v_exp_f32 v50, v50
    v_exp_f32 v51, v51
    v_mfma_f32_32x32x16_bf16 v[88:103], v[36:39], v[84:87], v[88:103]
    ds_read_b128 v[32:35], v128 offset:2048
    ds_read_b128 v[36:39], v128 offset:3072
    v_cvt_pk_bf16_f32 v76, v48, v49
    v_exp_f32 v52, v52
    v_exp_f32 v53, v53
    v_cvt_pk_bf16_f32 v77, v50, v51
    v_smfmac_f32_16x16x64_bf16 v[104:107], v[124:127], v[80:87], v215
    v_exp_f32 v54, v54
    v_exp_f32 v55, v55
    v_cvt_pk_bf16_f32 v78, v52, v53
    v_cvt_pk_bf16_f32 v79, v54, v55
    s_waitcnt lgkmcnt(2)
    v_mfma_f32_32x32x16_bf16 v[40:55], v[24:27], v[16:19], v[108:123]
    v_exp_f32 v56, v56
    v_exp_f32 v57, v57
    v_exp_f32 v58, v58
    v_exp_f32 v59, v59
    v_mfma_f32_32x32x16_bf16 v[40:55], v[28:31], v[20:23], v[40:55]
    ds_read_b128 v[24:27], v128 offset:12288
    ds_read_b128 v[28:31], v128 offset:13312
    v_cvt_pk_bf16_f32 v80, v56, v57
    v_exp_f32 v60, v60
    v_exp_f32 v61, v61
    v_cvt_pk_bf16_f32 v81, v58, v59
    s_waitcnt lgkmcnt(2)
    v_mfma_f32_32x32x16_bf16 v[88:103], v[32:35], v[72:75], v[88:103]
    v_exp_f32 v62, v62
    v_exp_f32 v63, v63
    v_cvt_pk_bf16_f32 v82, v60, v61
    v_exp_f32 v64, v64
    s_add_u32 m0, s28, 32768
    s_mov_b32 s29, 262144
    buffer_load_dwordx4 v216, s[12:15], s29 offen lds
    s_add_u32 m0, s28, 33792
    s_nop 0
    buffer_load_dwordx4 v217, s[12:15], s29 offen lds
    buffer_load_dword v220, v222, s[8:11], s60 offen offset:128 sc1
    v_exp_f32 v65, v65
    v_cvt_pk_bf16_f32 v83, v62, v63
    v_exp_f32 v66, v66
    v_exp_f32 v67, v67
    v_mfma_f32_32x32x16_bf16 v[88:103], v[36:39], v[76:79], v[88:103]
    ds_read_b128 v[32:35], v128 offset:6144
    ds_read_b128 v[36:39], v128 offset:7168
    v_cvt_pk_bf16_f32 v84, v64, v65
    v_exp_f32 v68, v68
    v_exp_f32 v69, v69
    v_cvt_pk_bf16_f32 v85, v66, v67
    v_smfmac_f32_16x16x64_bf16 v[104:107], v[124:127], v[72:79], v215
    v_exp_f32 v70, v70
    v_exp_f32 v71, v71
    v_cvt_pk_bf16_f32 v86, v68, v69
    v_cvt_pk_bf16_f32 v87, v70, v71
    s_waitcnt vmcnt(11)
    s_barrier
    s_waitcnt lgkmcnt(2)
    v_mfma_f32_32x32x16_bf16 v[56:71], v[24:27], v[16:19], v[108:123]
    v_exp_f32 v40, v40
    v_exp_f32 v41, v41
    v_exp_f32 v42, v42
    v_exp_f32 v43, v43
    v_mfma_f32_32x32x16_bf16 v[56:71], v[28:31], v[20:23], v[56:71]
    ds_read_b128 v[24:27], v129 offset:0
    ds_read_b128 v[28:31], v129 offset:1024
    v_cvt_pk_bf16_f32 v72, v40, v41
    v_exp_f32 v44, v44
    v_exp_f32 v45, v45
    v_cvt_pk_bf16_f32 v73, v42, v43
    s_waitcnt lgkmcnt(2)
    v_mfma_f32_32x32x16_bf16 v[88:103], v[32:35], v[80:83], v[88:103]
    v_exp_f32 v46, v46
    v_exp_f32 v47, v47
    v_cvt_pk_bf16_f32 v74, v44, v45
    v_exp_f32 v48, v48
    s_add_u32 m0, s28, 49152
    s_mov_b32 s29, 393216
    buffer_load_dwordx4 v216, s[12:15], s29 offen lds
    s_add_u32 m0, s28, 50176
    s_nop 0
    buffer_load_dwordx4 v217, s[12:15], s29 offen lds
    v_exp_f32 v49, v49
    v_cvt_pk_bf16_f32 v75, v46, v47
    v_exp_f32 v50, v50
    v_exp_f32 v51, v51
    v_mfma_f32_32x32x16_bf16 v[88:103], v[36:39], v[84:87], v[88:103]
    ds_read_b128 v[32:35], v128 offset:10240
    ds_read_b128 v[36:39], v128 offset:11264
    v_cvt_pk_bf16_f32 v76, v48, v49
    v_exp_f32 v52, v52
    v_exp_f32 v53, v53
    v_cvt_pk_bf16_f32 v77, v50, v51
    v_smfmac_f32_16x16x64_bf16 v[104:107], v[124:127], v[80:87], v215
    v_exp_f32 v54, v54
    v_exp_f32 v55, v55
    v_cvt_pk_bf16_f32 v78, v52, v53
    v_cvt_pk_bf16_f32 v79, v54, v55
    s_waitcnt lgkmcnt(2)
    v_mfma_f32_32x32x16_bf16 v[40:55], v[24:27], v[16:19], v[108:123]
    v_exp_f32 v56, v56
    v_exp_f32 v57, v57
    v_exp_f32 v58, v58
    v_exp_f32 v59, v59
    v_mfma_f32_32x32x16_bf16 v[40:55], v[28:31], v[20:23], v[40:55]
    ds_read_b128 v[24:27], v129 offset:4096
    ds_read_b128 v[28:31], v129 offset:5120
    v_cvt_pk_bf16_f32 v80, v56, v57
    v_exp_f32 v60, v60
    v_exp_f32 v61, v61
    v_cvt_pk_bf16_f32 v81, v58, v59
    s_waitcnt lgkmcnt(2)
    v_mfma_f32_32x32x16_bf16 v[88:103], v[32:35], v[72:75], v[88:103]
    v_exp_f32 v62, v62
    v_exp_f32 v63, v63
    v_cvt_pk_bf16_f32 v82, v60, v61
    v_exp_f32 v64, v64
    s_sub_u32 m0, s28, 71680
    s_mov_b32 s29, 524288
    buffer_load_dwordx4 v216, s[12:15], s29 offen lds
    s_sub_u32 m0, s28, 70656
    s_nop 0
    buffer_load_dwordx4 v217, s[12:15], s29 offen lds
    v_exp_f32 v65, v65
    v_cvt_pk_bf16_f32 v83, v62, v63
    v_exp_f32 v66, v66
    v_exp_f32 v67, v67
    v_mfma_f32_32x32x16_bf16 v[88:103], v[36:39], v[76:79], v[88:103]
    ds_read_b128 v[32:35], v128 offset:14336
    ds_read_b128 v[36:39], v128 offset:15360
    v_cvt_pk_bf16_f32 v84, v64, v65
    v_exp_f32 v68, v68
    v_exp_f32 v69, v69
    v_cvt_pk_bf16_f32 v85, v66, v67
    v_smfmac_f32_16x16x64_bf16 v[104:107], v[124:127], v[72:79], v215
    v_exp_f32 v70, v70
    v_exp_f32 v71, v71
    v_cvt_pk_bf16_f32 v86, v68, v69
    v_cvt_pk_bf16_f32 v87, v70, v71
    v_mov_b32 v128, v129
    v_add_u32 v129, 16384, v129
    v_and_b32 v129, 65535, v129
    s_waitcnt lgkmcnt(2)
    v_mfma_f32_32x32x16_bf16 v[56:71], v[24:27], v[16:19], v[108:123]
    v_exp_f32 v40, v40
    v_exp_f32 v41, v41
    v_exp_f32 v42, v42
    v_exp_f32 v43, v43
    v_mfma_f32_32x32x16_bf16 v[56:71], v[28:31], v[20:23], v[56:71]
    ds_read_b128 v[24:27], v128 offset:8192
    ds_read_b128 v[28:31], v128 offset:9216
    v_cvt_pk_bf16_f32 v72, v40, v41
    v_exp_f32 v44, v44
    v_exp_f32 v45, v45
    v_cvt_pk_bf16_f32 v73, v42, v43
    s_waitcnt lgkmcnt(2)
    v_mfma_f32_32x32x16_bf16 v[88:103], v[32:35], v[80:83], v[88:103]
    v_exp_f32 v46, v46
    v_exp_f32 v47, v47
    v_cvt_pk_bf16_f32 v74, v44, v45
    v_exp_f32 v48, v48
    v_exp_f32 v49, v49
    v_cvt_pk_bf16_f32 v75, v46, v47
    v_exp_f32 v50, v50
    v_exp_f32 v51, v51
    v_mfma_f32_32x32x16_bf16 v[88:103], v[36:39], v[84:87], v[88:103]
    ds_read_b128 v[32:35], v128 offset:2048
    ds_read_b128 v[36:39], v128 offset:3072
    v_cvt_pk_bf16_f32 v76, v48, v49
    v_exp_f32 v52, v52
    v_exp_f32 v53, v53
    v_cvt_pk_bf16_f32 v77, v50, v51
    v_smfmac_f32_16x16x64_bf16 v[104:107], v[124:127], v[80:87], v215
    v_exp_f32 v54, v54
    v_exp_f32 v55, v55
    v_cvt_pk_bf16_f32 v78, v52, v53
    v_cvt_pk_bf16_f32 v79, v54, v55
    s_waitcnt lgkmcnt(2)
    v_mfma_f32_32x32x16_bf16 v[40:55], v[24:27], v[16:19], v[108:123]
    v_exp_f32 v56, v56
    v_exp_f32 v57, v57
    v_exp_f32 v58, v58
    v_exp_f32 v59, v59
    v_mfma_f32_32x32x16_bf16 v[40:55], v[28:31], v[20:23], v[40:55]
    ds_read_b128 v[24:27], v128 offset:12288
    ds_read_b128 v[28:31], v128 offset:13312
    v_cvt_pk_bf16_f32 v80, v56, v57
    v_exp_f32 v60, v60
    v_exp_f32 v61, v61
    v_cvt_pk_bf16_f32 v81, v58, v59
    s_waitcnt lgkmcnt(2)
    v_mfma_f32_32x32x16_bf16 v[88:103], v[32:35], v[72:75], v[88:103]
    v_exp_f32 v62, v62
    v_exp_f32 v63, v63
    v_cvt_pk_bf16_f32 v82, v60, v61
    v_exp_f32 v64, v64
    v_exp_f32 v65, v65
    v_cvt_pk_bf16_f32 v83, v62, v63
    v_exp_f32 v66, v66
    v_exp_f32 v67, v67
    v_mfma_f32_32x32x16_bf16 v[88:103], v[36:39], v[76:79], v[88:103]
    ds_read_b128 v[32:35], v128 offset:6144
    ds_read_b128 v[36:39], v128 offset:7168
    v_cvt_pk_bf16_f32 v84, v64, v65
    v_exp_f32 v68, v68
    v_exp_f32 v69, v69
    v_cvt_pk_bf16_f32 v85, v66, v67
    v_smfmac_f32_16x16x64_bf16 v[104:107], v[124:127], v[72:79], v215
    v_exp_f32 v70, v70
    v_exp_f32 v71, v71
    v_cvt_pk_bf16_f32 v86, v68, v69
    v_cvt_pk_bf16_f32 v87, v70, v71
    s_waitcnt vmcnt(11)
    s_waitcnt vmcnt(2)
    v_cmp_ne_u32 vcc, s61, v220
    s_cbranch_vccnz M_ASPIN
M_AOK:
    s_barrier
    s_waitcnt lgkmcnt(2)
    v_mfma_f32_32x32x16_bf16 v[56:71], v[24:27], v[16:19], v[108:123]
    v_exp_f32 v40, v40
    v_exp_f32 v41, v41
    v_exp_f32 v42, v42
    v_exp_f32 v43, v43
    v_mfma_f32_32x32x16_bf16 v[56:71], v[28:31], v[20:23], v[56:71]
    ds_read_b128 v[24:27], v129 offset:0
    ds_read_b128 v[28:31], v129 offset:1024
    v_cvt_pk_bf16_f32 v72, v40, v41
    v_exp_f32 v44, v44
    v_exp_f32 v45, v45
    v_cvt_pk_bf16_f32 v73, v42, v43
    s_waitcnt lgkmcnt(2)
    v_mfma_f32_32x32x16_bf16 v[88:103], v[32:35], v[80:83], v[88:103]
    v_exp_f32 v46, v46
    v_exp_f32 v47, v47
    v_cvt_pk_bf16_f32 v74, v44, v45
    v_exp_f32 v48, v48
    s_sub_u32 m0, s28, 55296
    s_mov_b32 s29, 655360
    buffer_load_dwordx4 v216, s[12:15], s29 offen lds
    s_sub_u32 m0, s28, 54272
    s_nop 0
    buffer_load_dwordx4 v217, s[12:15], s29 offen lds
    s_add_u32 s22, s45, 0
    buffer_load_dwordx4 v[144:147], v131, s[8:11], s22 offen offset:0 sc1
    buffer_load_dwordx4 v[148:151], v131, s[8:11], s22 offen offset:1024 sc1
    buffer_load_dwordx4 v[152:155], v131, s[8:11], s22 offen offset:2048 sc1
    v_exp_f32 v49, v49
    v_cvt_pk_bf16_f32 v75, v46, v47
    v_exp_f32 v50, v50
    v_exp_f32 v51, v51
    v_mfma_f32_32x32x16_bf16 v[88:103], v[36:39], v[84:87], v[88:103]
    ds_read_b128 v[32:35], v128 offset:10240
    ds_read_b128 v[36:39], v128 offset:11264
    v_cvt_pk_bf16_f32 v76, v48, v49
    v_exp_f32 v52, v52
    v_exp_f32 v53, v53
    v_cvt_pk_bf16_f32 v77, v50, v51
    v_smfmac_f32_16x16x64_bf16 v[104:107], v[124:127], v[80:87], v215
    v_exp_f32 v54, v54
    v_exp_f32 v55, v55
    v_cvt_pk_bf16_f32 v78, v52, v53
    v_cvt_pk_bf16_f32 v79, v54, v55
    s_waitcnt lgkmcnt(2)
    v_mfma_f32_32x32x16_bf16 v[40:55], v[24:27], v[16:19], v[108:123]
    v_exp_f32 v56, v56
    v_exp_f32 v57, v57
    v_exp_f32 v58, v58
    v_exp_f32 v59, v59
    v_mfma_f32_32x32x16_bf16 v[40:55], v[28:31], v[20:23], v[40:55]
    ds_read_b128 v[24:27], v129 offset:4096
    ds_read_b128 v[28:31], v129 offset:5120
    v_cvt_pk_bf16_f32 v80, v56, v57
    v_exp_f32 v60, v60
    v_exp_f32 v61, v61
    v_cvt_pk_bf16_f32 v81, v58, v59
    s_waitcnt lgkmcnt(2)
    v_mfma_f32_32x32x16_bf16 v[88:103], v[32:35], v[72:75], v[88:103]
    v_exp_f32 v62, v62
    v_exp_f32 v63, v63
    v_cvt_pk_bf16_f32 v82, v60, v61
    v_exp_f32 v64, v64
    buffer_load_dwordx4 v[156:159], v131, s[8:11], s22 offen offset:3072 sc1
    s_add_u32 s22, s45, 4096
    buffer_load_dwordx4 v[160:163], v131, s[8:11], s22 offen offset:0 sc1
    buffer_load_dwordx4 v[164:167], v131, s[8:11], s22 offen offset:1024 sc1
    buffer_load_dwordx4 v[168:171], v131, s[8:11], s22 offen offset:2048 sc1
    v_exp_f32 v65, v65
    v_cvt_pk_bf16_f32 v83, v62, v63
    v_exp_f32 v66, v66
    v_exp_f32 v67, v67
    v_mfma_f32_32x32x16_bf16 v[88:103], v[36:39], v[76:79], v[88:103]
    ds_read_b128 v[32:35], v128 offset:14336
    ds_read_b128 v[36:39], v128 offset:15360
    v_cvt_pk_bf16_f32 v84, v64, v65
    v_exp_f32 v68, v68
    v_exp_f32 v69, v69
    v_cvt_pk_bf16_f32 v85, v66, v67
    v_smfmac_f32_16x16x64_bf16 v[104:107], v[124:127], v[72:79], v215
    v_exp_f32 v70, v70
    v_exp_f32 v71, v71
    v_cvt_pk_bf16_f32 v86, v68, v69
    v_cvt_pk_bf16_f32 v87, v70, v71
    v_mov_b32 v128, v129
    v_add_u32 v129, 16384, v129
    v_and_b32 v129, 65535, v129
    s_setprio 0
    s_cmp_lt_u32 s32, 4
    s_cbranch_scc1 M_P15_0
    s_setprio 1
M_P15_0:
    s_waitcnt lgkmcnt(2)
    v_mfma_f32_32x32x16_bf16 v[56:71], v[24:27], v[16:19], v[108:123]
    v_exp_f32 v40, v40
    v_exp_f32 v41, v41
    v_exp_f32 v42, v42
    v_exp_f32 v43, v43
    v_mfma_f32_32x32x16_bf16 v[56:71], v[28:31], v[20:23], v[56:71]
    ds_read_b128 v[24:27], v128 offset:8192
    ds_read_b128 v[28:31], v128 offset:9216
    v_cvt_pk_bf16_f32 v72, v40, v41
    v_exp_f32 v44, v44
    v_exp_f32 v45, v45
    v_cvt_pk_bf16_f32 v73, v42, v43
    s_waitcnt lgkmcnt(2)
    v_mfma_f32_32x32x16_bf16 v[88:103], v[32:35], v[80:83], v[88:103]
    v_exp_f32 v46, v46
    v_exp_f32 v47, v47
    v_cvt_pk_bf16_f32 v74, v44, v45
    v_exp_f32 v48, v48
    buffer_load_dwordx4 v[172:175], v131, s[8:11], s22 offen offset:3072 sc1
    s_add_u32 s22, s45, 8192
    buffer_load_dwordx4 v[176:179], v131, s[8:11], s22 offen offset:0 sc1
    buffer_load_dwordx4 v[180:183], v131, s[8:11], s22 offen offset:1024 sc1
    buffer_load_dwordx4 v[184:187], v131, s[8:11], s22 offen offset:2048 sc1
    v_exp_f32 v49, v49
    v_cvt_pk_bf16_f32 v75, v46, v47
    v_exp_f32 v50, v50
    v_exp_f32 v51, v51
    v_mfma_f32_32x32x16_bf16 v[88:103], v[36:39], v[84:87], v[88:103]
    ds_read_b128 v[32:35], v128 offset:2048
    ds_read_b128 v[36:39], v128 offset:3072
    v_cvt_pk_bf16_f32 v76, v48, v49
    v_exp_f32 v52, v52
    v_exp_f32 v53, v53
    v_cvt_pk_bf16_f32 v77, v50, v51
    v_smfmac_f32_16x16x64_bf16 v[104:107], v[124:127], v[80:87], v215
    v_exp_f32 v54, v54
    v_exp_f32 v55, v55
    v_cvt_pk_bf16_f32 v78, v52, v53
    v_cvt_pk_bf16_f32 v79, v54, v55
    s_waitcnt lgkmcnt(2)
    v_mfma_f32_32x32x16_bf16 v[40:55], v[24:27], v[16:19], v[108:123]
    v_exp_f32 v56, v56
    v_exp_f32 v57, v57
    v_exp_f32 v58, v58
    v_exp_f32 v59, v59
    v_mfma_f32_32x32x16_bf16 v[40:55], v[28:31], v[20:23], v[40:55]
    ds_read_b128 v[24:27], v128 offset:12288
    ds_read_b128 v[28:31], v128 offset:13312
    v_cvt_pk_bf16_f32 v80, v56, v57
    v_exp_f32 v60, v60
    v_exp_f32 v61, v61
    v_cvt_pk_bf16_f32 v81, v58, v59
    s_waitcnt lgkmcnt(2)
    v_mfma_f32_32x32x16_bf16 v[88:103], v[32:35], v[72:75], v[88:103]
    v_exp_f32 v62, v62
    v_exp_f32 v63, v63
    v_cvt_pk_bf16_f32 v82, v60, v61
    v_exp_f32 v64, v64
    buffer_load_dwordx4 v[188:191], v131, s[8:11], s22 offen offset:3072 sc1
    s_add_u32 s22, s45, 12288
    buffer_load_dwordx4 v[192:195], v131, s[8:11], s22 offen offset:0 sc1
    buffer_load_dwordx4 v[196:199], v131, s[8:11], s22 offen offset:1024 sc1
    v_exp_f32 v65, v65
    v_cvt_pk_bf16_f32 v83, v62, v63
    v_exp_f32 v66, v66
    v_exp_f32 v67, v67
    v_mfma_f32_32x32x16_bf16 v[88:103], v[36:39], v[76:79], v[88:103]
    ds_read_b128 v[32:35], v128 offset:6144
    ds_read_b128 v[36:39], v128 offset:7168
    v_cvt_pk_bf16_f32 v84, v64, v65
    v_exp_f32 v68, v68
    v_exp_f32 v69, v69
    v_cvt_pk_bf16_f32 v85, v66, v67
    v_smfmac_f32_16x16x64_bf16 v[104:107], v[124:127], v[72:79], v215
    v_exp_f32 v70, v70
    v_exp_f32 v71, v71
    v_cvt_pk_bf16_f32 v86, v68, v69
    v_cvt_pk_bf16_f32 v87, v70, v71
    s_waitcnt lgkmcnt(2)
    v_mfma_f32_32x32x16_bf16 v[56:71], v[24:27], v[16:19], v[108:123]
    v_exp_f32 v40, v40
    v_exp_f32 v41, v41
    v_exp_f32 v42, v42
    v_exp_f32 v43, v43
    v_mfma_f32_32x32x16_bf16 v[56:71], v[28:31], v[20:23], v[56:71]
    v_cvt_pk_bf16_f32 v72, v40, v41
    v_exp_f32 v44, v44
    v_exp_f32 v45, v45
    v_cvt_pk_bf16_f32 v73, v42, v43
    s_waitcnt lgkmcnt(0)
    v_mfma_f32_32x32x16_bf16 v[88:103], v[32:35], v[80:83], v[88:103]
    v_exp_f32 v46, v46
    v_exp_f32 v47, v47
    v_cvt_pk_bf16_f32 v74, v44, v45
    v_exp_f32 v48, v48
    buffer_load_dwordx4 v[200:203], v131, s[8:11], s22 offen offset:2048 sc1
    buffer_load_dwordx4 v[204:207], v131, s[8:11], s22 offen offset:3072 sc1
    s_add_u32 s22, s45, 16384
    buffer_load_dwordx4 v[224:227], v131, s[8:11], s22 offen offset:0 sc1
    v_exp_f32 v49, v49
    v_cvt_pk_bf16_f32 v75, v46, v47
    v_exp_f32 v50, v50
    v_exp_f32 v51, v51
    v_mfma_f32_32x32x16_bf16 v[88:103], v[36:39], v[84:87], v[88:103]
    ds_read_b128 v[32:35], v128 offset:10240
    ds_read_b128 v[36:39], v128 offset:11264
    v_cvt_pk_bf16_f32 v76, v48, v49
    v_exp_f32 v52, v52
    v_exp_f32 v53, v53
    v_cvt_pk_bf16_f32 v77, v50, v51
    v_smfmac_f32_16x16x64_bf16 v[104:107], v[124:127], v[80:87], v215
    v_exp_f32 v54, v54
    v_exp_f32 v55, v55
    v_cvt_pk_bf16_f32 v78, v52, v53
    v_cvt_pk_bf16_f32 v79, v54, v55
    v_exp_f32 v56, v56
    v_exp_f32 v57, v57
    v_exp_f32 v58, v58
    v_exp_f32 v59, v59
    v_cvt_pk_bf16_f32 v80, v56, v57
    v_exp_f32 v60, v60
    v_exp_f32 v61, v61
    v_cvt_pk_bf16_f32 v81, v58, v59
    s_waitcnt lgkmcnt(0)
    v_mfma_f32_32x32x16_bf16 v[88:103], v[32:35], v[72:75], v[88:103]
    v_exp_f32 v62, v62
    v_exp_f32 v63, v63
    v_cvt_pk_bf16_f32 v82, v60, v61
    v_exp_f32 v64, v64
    buffer_load_dwordx4 v[228:231], v131, s[8:11], s22 offen offset:1024 sc1
    buffer_load_dwordx4 v[232:235], v131, s[8:11], s22 offen offset:2048 sc1
    buffer_load_dwordx4 v[236:239], v131, s[8:11], s22 offen offset:3072 sc1
    v_exp_f32 v65, v65
    v_cvt_pk_bf16_f32 v83, v62, v63
    v_exp_f32 v66, v66
    v_exp_f32 v67, v67
    v_mfma_f32_32x32x16_bf16 v[88:103], v[36:39], v[76:79], v[88:103]
    ds_read_b128 v[32:35], v128 offset:14336
    ds_read_b128 v[36:39], v128 offset:15360
    v_cvt_pk_bf16_f32 v84, v64, v65
    v_exp_f32 v68, v68
    v_exp_f32 v69, v69
    v_cvt_pk_bf16_f32 v85, v66, v67
    v_smfmac_f32_16x16x64_bf16 v[104:107], v[124:127], v[72:79], v215
    v_exp_f32 v70, v70
    v_exp_f32 v71, v71
    v_cvt_pk_bf16_f32 v86, v68, v69
    v_cvt_pk_bf16_f32 v87, v70, v71
    s_waitcnt lgkmcnt(0)
    v_mfma_f32_32x32x16_bf16 v[88:103], v[32:35], v[80:83], v[88:103]
    v_smfmac_f32_16x16x64_bf16 v[104:107], v[124:127], v[80:87], v215
    v_mfma_f32_32x32x16_bf16 v[88:103], v[36:39], v[84:87], v[88:103]
    s_nop 6
    v_add_f32 v104, v104, v105
    s_nop 3
    v_pk_add_f32 v[40:41], v[88:89], v[90:91]
    v_pk_add_f32 v[42:43], v[92:93], v[94:95]
    v_pk_add_f32 v[44:45], v[96:97], v[98:99]
    v_pk_add_f32 v[46:47], v[100:101], v[102:103]
    v_pk_add_f32 v[40:41], v[40:41], v[42:43]
    v_pk_add_f32 v[44:45], v[44:45], v[46:47]
    v_pk_add_f32 v[40:41], v[40:41], v[44:45]
    v_add_f32 v2, v40, v41
    s_mov_b32 s40, 0x11800000
    s_mov_b32 s41, 0x76800000
    s_mov_b32 s42, 0x7e800000
    v_cmp_ge_f32 s[46:47], v104, s40
    v_cmp_le_f32 s[48:49], v104, s41
    v_cmp_ge_f32 vcc, s42, |v2|
    s_nop 4
    s_and_b64 s[46:47], s[46:47], s[48:49]
    s_and_b64 s[46:47], s[46:47], vcc
    s_cmp_eq_u64 s[46:47], -1
    s_cbranch_scc0 K2_SLOW
K2_FIN:
    v_rcp_f32 v2, v104
    v_sub_f32 v3, 1.0, v214
    v_mul_f32 v2, v2, v3
    v_mul_f32 v88, v88, v2
    v_mul_f32 v89, v89, v2
    v_mul_f32 v90, v90, v2
    v_mul_f32 v91, v91, v2
    v_mul_f32 v92, v92, v2
    v_mul_f32 v93, v93, v2
    v_mul_f32 v94, v94, v2
    v_mul_f32 v95, v95, v2
    v_mul_f32 v96, v96, v2
    v_mul_f32 v97, v97, v2
    v_mul_f32 v98, v98, v2
    v_mul_f32 v99, v99, v2
    v_mul_f32 v100, v100, v2
    v_mul_f32 v101, v101, v2
    v_mul_f32 v102, v102, v2
    v_mul_f32 v103, v103, v2
    v_cvt_pk_bf16_f32 v88, v88, v89
    v_cvt_pk_bf16_f32 v89, v90, v91
    v_cvt_pk_bf16_f32 v90, v92, v93
    v_cvt_pk_bf16_f32 v91, v94, v95
    v_cvt_pk_bf16_f32 v92, v96, v97
    v_cvt_pk_bf16_f32 v93, v98, v99
    v_cvt_pk_bf16_f32 v94, v100, v101
    v_cvt_pk_bf16_f32 v95, v102, v103
    buffer_store_dwordx4 v[88:91], v131, s[8:11], s24 offen offset:0 sc1
    buffer_store_dwordx4 v[92:95], v131, s[8:11], s24 offen offset:1024 sc1
    s_setprio 0
    s_and_b32 s3, s2, 7
    s_lshr_b32 s40, s2, 3
    s_lshr_b32 s35, s3, 1
    s_lshl_b32 s35, s35, 2
    s_and_b32 s41, s40, 3
    s_add_u32 s35, s35, s41
    s_and_b32 s36, s3, 1
    s_lshl_b32 s36, s36, 3
    s_lshr_b32 s41, s40, 2
    s_add_u32 s36, s36, s41
    s_and_b32 s33, s32, 3
    s_lshr_b32 s34, s32, 2
    s_lshl_b32 s40, s35, 2
    s_add_u32 s40, s40, s33
    v_and_b32 v4, 31, v1
    s_lshl_b32 s41, s40, 5
    v_add_u32 v10, s41, v4
    v_lshrrev_b32 v3, 5, v1
    v_bfe_u32 v6, v1, 2, 2
    v_lshl_add_u32 v7, v3, 2, v6
    v_lshlrev_b32 v7, 7, v7
    v_lshrrev_b32 v8, 1, v6
    v_lshl_add_u32 v7, v8, 6, v7
    v_bfe_u32 v8, v1, 4, 1
    v_lshl_add_u32 v7, v8, 5, v7
    v_and_b32 v8, 3, v1
    v_lshl_add_u32 v7, v8, 3, v7
    s_lshl_b32 s40, s34, 13
    s_add_u32 s40, s40, 71680
    v_add_u32 v128, s40, v7
    s_lshl_b32 s40, s34, 6
    v_xor_b32 v128, s40, v128
    v_xor_b32 v129, 64, v128
    v_subrev_u32 v14, 71680, v128
    v_subrev_u32 v15, 71680, v129
    s_lshl_b32 s40, s32, 12
    s_add_u32 s41, s40, 0
    v_add_u32 v133, s41, v131
    v_xor_b32 v134, 16384, v133
    v_lshlrev_b32 v10, 11, v10
    v_lshl_add_u32 v135, v3, 4, v10
    s_lshl_b32 s43, s36, 7
    s_lshl_b32 s40, s34, 6
    s_add_u32 s43, s43, s40
    s_lshl_b32 s40, s32, 11
    s_add_u32 s40, s40, 71680
    v_lshlrev_b32 v11, 6, v4
    v_lshl_add_u32 v11, v3, 3, v11
    v_add_u32 v11, s40, v11
    v_bfe_u32 v12, v4, 1, 2
    v_xor_b32 v13, 0, v12
    v_lshl_add_u32 v136, v13, 4, v11
    v_xor_b32 v13, 1, v12
    v_lshl_add_u32 v137, v13, 4, v11
    v_xor_b32 v13, 2, v12
    v_lshl_add_u32 v138, v13, 4, v11
    v_xor_b32 v13, 3, v12
    v_lshl_add_u32 v139, v13, 4, v11
    v_lshrrev_b32 v11, 2, v1
    v_bfe_u32 v12, v1, 3, 2
    v_and_b32 v13, 3, v1
    v_xor_b32 v12, v12, v13
    v_lshlrev_b32 v12, 4, v12
    v_lshl_add_u32 v12, v11, 6, v12
    v_add_u32 v140, s40, v12
    s_lshl_b32 s40, s35, 2
    s_add_u32 s40, s40, s33
    s_lshl_b32 s40, s40, 5
    v_add_u32 v11, s40, v11
    v_lshlrev_b32 v11, 11, v11
    v_lshl_add_u32 v135, v13, 4, v11
    s_add_u32 s41, s43, 32768
    s_mov_b32 s44, s41
    s_mov_b32 s47, 24117248
    ds_read_b64_tr_b16 v[48:49], v128 offset:0
    ds_read_b64_tr_b16 v[50:51], v128 offset:1024
    ds_read_b64_tr_b16 v[52:53], v129 offset:0
    ds_read_b64_tr_b16 v[54:55], v129 offset:1024
    s_waitcnt lgkmcnt(0)
    s_waitcnt vmcnt(21)
    v_mfma_f32_32x32x16_bf16 v[16:31], v[48:51], v[144:147], 0
    ds_read_b64_tr_b16 v[56:57], v128 offset:2048
    ds_read_b64_tr_b16 v[58:59], v128 offset:3072
    v_mfma_f32_32x32x16_bf16 v[32:47], v[52:55], v[144:147], 0
    ds_read_b64_tr_b16 v[60:61], v129 offset:2048
    ds_read_b64_tr_b16 v[62:63], v129 offset:3072
    s_add_u32 s22, s45, 20480
    buffer_load_dwordx4 v[144:147], v131, s[8:11], s22 offen offset:0 sc1
    s_waitcnt lgkmcnt(0)
    s_waitcnt vmcnt(21)
    v_mfma_f32_32x32x16_bf16 v[16:31], v[56:59], v[148:151], v[16:31]
    ds_read_b64_tr_b16 v[48:49], v128 offset:4096
    ds_read_b64_tr_b16 v[50:51], v128 offset:5120
    v_mfma_f32_32x32x16_bf16 v[32:47], v[60:63], v[148:151], v[32:47]
    ds_read_b64_tr_b16 v[52:53], v129 offset:4096
    ds_read_b64_tr_b16 v[54:55], v129 offset:5120
    s_waitcnt lgkmcnt(0)
    s_waitcnt vmcnt(20)
    v_mfma_f32_32x32x16_bf16 v[16:31], v[48:51], v[152:155], v[16:31]
    ds_read_b64_tr_b16 v[56:57], v128 offset:6144
    ds_read_b64_tr_b16 v[58:59], v128 offset:7168
    v_mfma_f32_32x32x16_bf16 v[32:47], v[52:55], v[152:155], v[32:47]
    ds_read_b64_tr_b16 v[60:61], v129 offset:6144
    ds_read_b64_tr_b16 v[62:63], v129 offset:7168
    buffer_load_dwordx4 v[148:151], v131, s[8:11], s22 offen offset:1024 sc1
    s_waitcnt vmcnt(2)
    s_waitcnt lgkmcnt(0)
    s_barrier
    s_cmp_lg_u32 s32, 0
    s_cbranch_scc1 K23_GO
    s_mov_b32 exec_hi, 0
    buffer_store_dword v221, v218, s[8:11], s47 offen sc1
    s_mov_b32 exec_hi, -1
K23_GO:
    v_mfma_f32_32x32x16_bf16 v[16:31], v[56:59], v[156:159], v[16:31]
    ds_read_b64_tr_b16 v[48:49], v128 offset:16384
    ds_read_b64_tr_b16 v[50:51], v128 offset:17408
    v_mfma_f32_32x32x16_bf16 v[32:47], v[60:63], v[156:159], v[32:47]
    ds_read_b64_tr_b16 v[52:53], v129 offset:16384
    ds_read_b64_tr_b16 v[54:55], v129 offset:17408
    s_sub_u32 m0, s28, 38912
    s_mov_b32 s29, 786432
    buffer_load_dwordx4 v216, s[12:15], s29 offen lds
    s_sub_u32 m0, s28, 37888
    s_nop 0
    buffer_load_dwordx4 v217, s[12:15], s29 offen lds
    s_sub_u32 m0, s28, 22528
    s_mov_b32 s29, 917504
    buffer_load_dwordx4 v216, s[12:15], s29 offen lds
    s_sub_u32 m0, s28, 21504
    s_nop 0
    buffer_load_dwordx4 v217, s[12:15], s29 offen lds
    s_waitcnt lgkmcnt(0)
    v_mfma_f32_32x32x16_bf16 v[16:31], v[48:51], v[160:163], v[16:31]
    ds_read_b64_tr_b16 v[56:57], v128 offset:18432
    ds_read_b64_tr_b16 v[58:59], v128 offset:19456
    v_mfma_f32_32x32x16_bf16 v[32:47], v[52:55], v[160:163], v[32:47]
    ds_read_b64_tr_b16 v[60:61], v129 offset:18432
    ds_read_b64_tr_b16 v[62:63], v129 offset:19456
    buffer_load_dwordx4 v[152:155], v131, s[8:11], s22 offen offset:2048 sc1
    s_waitcnt lgkmcnt(0)
    v_mfma_f32_32x32x16_bf16 v[16:31], v[56:59], v[164:167], v[16:31]
    ds_read_b64_tr_b16 v[48:49], v128 offset:20480
    ds_read_b64_tr_b16 v[50:51], v128 offset:21504
    v_mfma_f32_32x32x16_bf16 v[32:47], v[60:63], v[164:167], v[32:47]
    ds_read_b64_tr_b16 v[52:53], v129 offset:20480
    ds_read_b64_tr_b16 v[54:55], v129 offset:21504
    s_waitcnt lgkmcnt(0)
    v_mfma_f32_32x32x16_bf16 v[16:31], v[48:51], v[168:171], v[16:31]
    ds_read_b64_tr_b16 v[56:57], v128 offset:22528
    ds_read_b64_tr_b16 v[58:59], v128 offset:23552
    v_mfma_f32_32x32x16_bf16 v[32:47], v[52:55], v[168:171], v[32:47]
    ds_read_b64_tr_b16 v[60:61], v129 offset:22528
    ds_read_b64_tr_b16 v[62:63], v129 offset:23552
    buffer_load_dwordx4 v[156:159], v131, s[8:11], s22 offen offset:3072 sc1
    s_waitcnt lgkmcnt(0)
    s_barrier
    v_mfma_f32_32x32x16_bf16 v[16:31], v[56:59], v[172:175], v[16:31]
    ds_read_b64_tr_b16 v[48:49], v128 offset:32768
    ds_read_b64_tr_b16 v[50:51], v128 offset:33792
    v_mfma_f32_32x32x16_bf16 v[32:47], v[60:63], v[172:175], v[32:47]
    ds_read_b64_tr_b16 v[52:53], v129 offset:32768
    ds_read_b64_tr_b16 v[54:55], v129 offset:33792
    s_mov_b32 s12, s58
    s_mov_b32 s13, s59
    s_add_u32 m0, s28, 0
    s_mov_b32 s29, 0
    buffer_load_dwordx4 v216, s[12:15], s29 offen lds
    s_add_u32 m0, s28, 1024
    s_nop 0
    buffer_load_dwordx4 v217, s[12:15], s29 offen lds
    s_add_u32 m0, s28, 16384
    s_mov_b32 s29, 131072
    buffer_load_dwordx4 v216, s[12:15], s29 offen lds
    s_add_u32 m0, s28, 17408
    s_nop 0
    buffer_load_dwordx4 v217, s[12:15], s29 offen lds
    s_waitcnt lgkmcnt(0)
    v_mfma_f32_32x32x16_bf16 v[16:31], v[48:51], v[176:179], v[16:31]
    ds_read_b64_tr_b16 v[56:57], v128 offset:34816
    ds_read_b64_tr_b16 v[58:59], v128 offset:35840
    v_mfma_f32_32x32x16_bf16 v[32:47], v[52:55], v[176:179], v[32:47]
    ds_read_b64_tr_b16 v[60:61], v129 offset:34816
    ds_read_b64_tr_b16 v[62:63], v129 offset:35840
    s_add_u32 s22, s45, 24576
    buffer_load_dwordx4 v[160:163], v131, s[8:11], s22 offen offset:0 sc1
    s_waitcnt lgkmcnt(0)
    v_mfma_f32_32x32x16_bf16 v[16:31], v[56:59], v[180:183], v[16:31]
    ds_read_b64_tr_b16 v[48:49], v128 offset:36864
    ds_read_b64_tr_b16 v[50:51], v128 offset:37888
    v_mfma_f32_32x32x16_bf16 v[32:47], v[60:63], v[180:183], v[32:47]
    ds_read_b64_tr_b16 v[52:53], v129 offset:36864
    ds_read_b64_tr_b16 v[54:55], v129 offset:37888
    s_waitcnt lgkmcnt(0)
    v_mfma_f32_32x32x16_bf16 v[16:31], v[48:51], v[184:187], v[16:31]
    ds_read_b64_tr_b16 v[56:57], v128 offset:38912
    ds_read_b64_tr_b16 v[58:59], v128 offset:39936
    v_mfma_f32_32x32x16_bf16 v[32:47], v[52:55], v[184:187], v[32:47]
    ds_read_b64_tr_b16 v[60:61], v129 offset:38912
    ds_read_b64_tr_b16 v[62:63], v129 offset:39936
    buffer_load_dwordx4 v[164:167], v131, s[8:11], s22 offen offset:1024 sc1
    s_waitcnt lgkmcnt(0)
    s_barrier
    v_mfma_f32_32x32x16_bf16 v[16:31], v[56:59], v[188:191], v[16:31]
    ds_read_b64_tr_b16 v[48:49], v128 offset:49152
    ds_read_b64_tr_b16 v[50:51], v128 offset:50176
    v_mfma_f32_32x32x16_bf16 v[32:47], v[60:63], v[188:191], v[32:47]
    ds_read_b64_tr_b16 v[52:53], v129 offset:49152
    ds_read_b64_tr_b16 v[54:55], v129 offset:50176
    s_add_u32 m0, s28, 32768
    s_mov_b32 s29, 262144
    buffer_load_dwordx4 v216, s[12:15], s29 offen lds
    s_add_u32 m0, s28, 33792
    s_nop 0
    buffer_load_dwordx4 v217, s[12:15], s29 offen lds
    s_waitcnt lgkmcnt(0)
    v_mfma_f32_32x32x16_bf16 v[16:31], v[48:51], v[192:195], v[16:31]
    ds_read_b64_tr_b16 v[56:57], v128 offset:51200
    ds_read_b64_tr_b16 v[58:59], v128 offset:52224
    v_mfma_f32_32x32x16_bf16 v[32:47], v[52:55], v[192:195], v[32:47]
    ds_read_b64_tr_b16 v[60:61], v129 offset:51200
    ds_read_b64_tr_b16 v[62:63], v129 offset:52224
    buffer_load_dwordx4 v[168:171], v131, s[8:11], s22 offen offset:2048 sc1
    s_waitcnt lgkmcnt(0)
    v_mfma_f32_32x32x16_bf16 v[16:31], v[56:59], v[196:199], v[16:31]
    ds_read_b64_tr_b16 v[48:49], v128 offset:53248
    ds_read_b64_tr_b16 v[50:51], v128 offset:54272
    v_mfma_f32_32x32x16_bf16 v[32:47], v[60:63], v[196:199], v[32:47]
    ds_read_b64_tr_b16 v[52:53], v129 offset:53248
    ds_read_b64_tr_b16 v[54:55], v129 offset:54272
    s_waitcnt lgkmcnt(0)
    v_mfma_f32_32x32x16_bf16 v[16:31], v[48:51], v[200:203], v[16:31]
    ds_read_b64_tr_b16 v[56:57], v128 offset:55296
    ds_read_b64_tr_b16 v[58:59], v128 offset:56320
    v_mfma_f32_32x32x16_bf16 v[32:47], v[52:55], v[200:203], v[32:47]
    ds_read_b64_tr_b16 v[60:61], v129 offset:55296
    ds_read_b64_tr_b16 v[62:63], v129 offset:56320
    buffer_load_dwordx4 v[172:175], v131, s[8:11], s22 offen offset:3072 sc1
    s_waitcnt lgkmcnt(0)
    s_barrier
    v_mfma_f32_32x32x16_bf16 v[16:31], v[56:59], v[204:207], v[16:31]
    ds_read_b64_tr_b16 v[48:49], v14 offset:0
    ds_read_b64_tr_b16 v[50:51], v14 offset:1024
    v_mfma_f32_32x32x16_bf16 v[32:47], v[60:63], v[204:207], v[32:47]
    ds_read_b64_tr_b16 v[52:53], v15 offset:0
    ds_read_b64_tr_b16 v[54:55], v15 offset:1024
    s_add_u32 m0, s28, 49152
    s_mov_b32 s29, 393216
    buffer_load_dwordx4 v216, s[12:15], s29 offen lds
    s_add_u32 m0, s28, 50176
    s_nop 0
    buffer_load_dwordx4 v217, s[12:15], s29 offen lds
    s_waitcnt lgkmcnt(0)
    v_mfma_f32_32x32x16_bf16 v[16:31], v[48:51], v[224:227], v[16:31]
    ds_read_b64_tr_b16 v[56:57], v14 offset:2048
    ds_read_b64_tr_b16 v[58:59], v14 offset:3072
    v_mfma_f32_32x32x16_bf16 v[32:47], v[52:55], v[224:227], v[32:47]
    ds_read_b64_tr_b16 v[60:61], v15 offset:2048
    ds_read_b64_tr_b16 v[62:63], v15 offset:3072
    s_add_u32 s22, s45, 28672
    buffer_load_dwordx4 v[176:179], v131, s[8:11], s22 offen offset:0 sc1
    s_waitcnt lgkmcnt(0)
    v_mfma_f32_32x32x16_bf16 v[16:31], v[56:59], v[228:231], v[16:31]
    ds_read_b64_tr_b16 v[48:49], v14 offset:4096
    ds_read_b64_tr_b16 v[50:51], v14 offset:5120
    v_mfma_f32_32x32x16_bf16 v[32:47], v[60:63], v[228:231], v[32:47]
    ds_read_b64_tr_b16 v[52:53], v15 offset:4096
    ds_read_b64_tr_b16 v[54:55], v15 offset:5120
    buffer_load_dword v220, v222, s[8:11], s60 offen offset:0 sc1
    s_waitcnt lgkmcnt(0)
    v_mfma_f32_32x32x16_bf16 v[16:31], v[48:51], v[232:235], v[16:31]
    ds_read_b64_tr_b16 v[56:57], v14 offset:6144
    ds_read_b64_tr_b16 v[58:59], v14 offset:7168
    v_mfma_f32_32x32x16_bf16 v[32:47], v[52:55], v[232:235], v[32:47]
    ds_read_b64_tr_b16 v[60:61], v15 offset:6144
    ds_read_b64_tr_b16 v[62:63], v15 offset:7168
    buffer_load_dwordx4 v[180:183], v131, s[8:11], s22 offen offset:1024 sc1
    s_waitcnt lgkmcnt(0)
    s_barrier
    v_mfma_f32_32x32x16_bf16 v[16:31], v[56:59], v[236:239], v[16:31]
    ds_read_b64_tr_b16 v[48:49], v14 offset:16384
    ds_read_b64_tr_b16 v[50:51], v14 offset:17408
    v_mfma_f32_32x32x16_bf16 v[32:47], v[60:63], v[236:239], v[32:47]
    ds_read_b64_tr_b16 v[52:53], v15 offset:16384
    ds_read_b64_tr_b16 v[54:55], v15 offset:17408
    s_sub_u32 m0, s28, 71680
    s_mov_b32 s29, 524288
    buffer_load_dwordx4 v216, s[12:15], s29 offen lds
    s_sub_u32 m0, s28, 70656
    s_nop 0
    buffer_load_dwordx4 v217, s[12:15], s29 offen lds
    s_waitcnt lgkmcnt(0)
    s_waitcnt vmcnt(24)
    v_mfma_f32_32x32x16_bf16 v[16:31], v[48:51], v[144:147], v[16:31]
    ds_read_b64_tr_b16 v[56:57], v14 offset:18432
    ds_read_b64_tr_b16 v[58:59], v14 offset:19456
    v_mfma_f32_32x32x16_bf16 v[32:47], v[52:55], v[144:147], v[32:47]
    ds_read_b64_tr_b16 v[60:61], v15 offset:18432
    ds_read_b64_tr_b16 v[62:63], v15 offset:19456
    buffer_load_dwordx4 v[184:187], v131, s[8:11], s22 offen offset:2048 sc1
    s_waitcnt lgkmcnt(0)
    s_waitcnt vmcnt(24)
    v_mfma_f32_32x32x16_bf16 v[16:31], v[56:59], v[148:151], v[16:31]
    ds_read_b64_tr_b16 v[48:49], v14 offset:20480
    ds_read_b64_tr_b16 v[50:51], v14 offset:21504
    v_mfma_f32_32x32x16_bf16 v[32:47], v[60:63], v[148:151], v[32:47]
    ds_read_b64_tr_b16 v[52:53], v15 offset:20480
    ds_read_b64_tr_b16 v[54:55], v15 offset:21504
    s_waitcnt lgkmcnt(0)
    s_waitcnt vmcnt(19)
    v_mfma_f32_32x32x16_bf16 v[16:31], v[48:51], v[152:155], v[16:31]
    ds_read_b64_tr_b16 v[56:57], v14 offset:22528
    ds_read_b64_tr_b16 v[58:59], v14 offset:23552
    v_mfma_f32_32x32x16_bf16 v[32:47], v[52:55], v[152:155], v[32:47]
    ds_read_b64_tr_b16 v[60:61], v15 offset:22528
    ds_read_b64_tr_b16 v[62:63], v15 offset:23552
    buffer_load_dwordx4 v[188:191], v131, s[8:11], s22 offen offset:3072 sc1
    s_waitcnt vmcnt(5)
    v_cmp_ne_u32 vcc, s61, v220
    s_cbranch_vccnz M_BSPIN
M_BOK:
    s_waitcnt lgkmcnt(0)
    s_barrier
    v_mfma_f32_32x32x16_bf16 v[16:31], v[56:59], v[156:159], v[16:31]
    ds_read_b64_tr_b16 v[48:49], v14 offset:32768
    ds_read_b64_tr_b16 v[50:51], v14 offset:33792
    v_mfma_f32_32x32x16_bf16 v[32:47], v[60:63], v[156:159], v[32:47]
    ds_read_b64_tr_b16 v[52:53], v15 offset:32768
    ds_read_b64_tr_b16 v[54:55], v15 offset:33792
    s_sub_u32 m0, s28, 55296
    s_mov_b32 s29, 655360
    buffer_load_dwordx4 v216, s[12:15], s29 offen lds
    s_sub_u32 m0, s28, 54272
    s_nop 0
    buffer_load_dwordx4 v217, s[12:15], s29 offen lds
    s_add_u32 s45, s45, 65536
    s_add_u32 s22, s45, 0
    buffer_load_dwordx4 v[192:195], v131, s[8:11], s22 offen offset:0 sc1
    s_waitcnt lgkmcnt(0)
    v_mfma_f32_32x32x16_bf16 v[16:31], v[48:51], v[160:163], v[16:31]
    ds_read_b64_tr_b16 v[56:57], v14 offset:34816
    ds_read_b64_tr_b16 v[58:59], v14 offset:35840
    v_mfma_f32_32x32x16_bf16 v[32:47], v[52:55], v[160:163], v[32:47]
    ds_read_b64_tr_b16 v[60:61], v15 offset:34816
    ds_read_b64_tr_b16 v[62:63], v15 offset:35840
    buffer_load_dwordx4 v[196:199], v131, s[8:11], s22 offen offset:1024 sc1
    s_waitcnt lgkmcnt(0)
    v_mfma_f32_32x32x16_bf16 v[16:31], v[56:59], v[164:167], v[16:31]
    ds_read_b64_tr_b16 v[48:49], v14 offset:36864
    ds_read_b64_tr_b16 v[50:51], v14 offset:37888
    v_mfma_f32_32x32x16_bf16 v[32:47], v[60:63], v[164:167], v[32:47]
    ds_read_b64_tr_b16 v[52:53], v15 offset:36864
    ds_read_b64_tr_b16 v[54:55], v15 offset:37888
    buffer_load_dwordx4 v[200:203], v131, s[8:11], s22 offen offset:2048 sc1
    s_waitcnt lgkmcnt(0)
    v_mfma_f32_32x32x16_bf16 v[16:31], v[48:51], v[168:171], v[16:31]
    ds_read_b64_tr_b16 v[56:57], v14 offset:38912
    ds_read_b64_tr_b16 v[58:59], v14 offset:39936
    v_mfma_f32_32x32x16_bf16 v[32:47], v[52:55], v[168:171], v[32:47]
    ds_read_b64_tr_b16 v[60:61], v15 offset:38912
    ds_read_b64_tr_b16 v[62:63], v15 offset:39936
    buffer_load_dwordx4 v[204:207], v131, s[8:11], s22 offen offset:3072 sc1
    s_waitcnt lgkmcnt(0)
    s_barrier
    v_mfma_f32_32x32x16_bf16 v[16:31], v[56:59], v[172:175], v[16:31]
    ds_read_b64_tr_b16 v[48:49], v14 offset:49152
    ds_read_b64_tr_b16 v[50:51], v14 offset:50176
    v_mfma_f32_32x32x16_bf16 v[32:47], v[60:63], v[172:175], v[32:47]
    ds_read_b64_tr_b16 v[52:53], v15 offset:49152
    ds_read_b64_tr_b16 v[54:55], v15 offset:50176
    s_sub_u32 m0, s28, 38912
    s_mov_b32 s29, 786432
    buffer_load_dwordx4 v216, s[12:15], s29 offen lds
    s_sub_u32 m0, s28, 37888
    s_nop 0
    buffer_load_dwordx4 v217, s[12:15], s29 offen lds
    s_add_u32 s22, s45, 4096
    buffer_load_dwordx4 v[224:227], v131, s[8:11], s22 offen offset:0 sc1
    s_waitcnt lgkmcnt(0)
    v_mfma_f32_32x32x16_bf16 v[16:31], v[48:51], v[176:179], v[16:31]
    ds_read_b64_tr_b16 v[56:57], v14 offset:51200
    ds_read_b64_tr_b16 v[58:59], v14 offset:52224
    v_mfma_f32_32x32x16_bf16 v[32:47], v[52:55], v[176:179], v[32:47]
    ds_read_b64_tr_b16 v[60:61], v15 offset:51200
    ds_read_b64_tr_b16 v[62:63], v15 offset:52224
    buffer_load_dwordx4 v[228:231], v131, s[8:11], s22 offen offset:1024 sc1
    buffer_load_dwordx4 v[232:235], v131, s[8:11], s22 offen offset:2048 sc1
    s_waitcnt lgkmcnt(0)
    s_waitcnt vmcnt(15)
    v_mfma_f32_32x32x16_bf16 v[16:31], v[56:59], v[180:183], v[16:31]
    ds_read_b64_tr_b16 v[48:49], v14 offset:53248
    ds_read_b64_tr_b16 v[50:51], v14 offset:54272
    v_mfma_f32_32x32x16_bf16 v[32:47], v[60:63], v[180:183], v[32:47]
    ds_read_b64_tr_b16 v[52:53], v15 offset:53248
    ds_read_b64_tr_b16 v[54:55], v15 offset:54272
    buffer_load_dwordx4 v[236:239], v131, s[8:11], s22 offen offset:3072 sc1
    s_waitcnt lgkmcnt(0)
    s_waitcnt vmcnt(13)
    v_mfma_f32_32x32x16_bf16 v[16:31], v[48:51], v[184:187], v[16:31]
    ds_read_b64_tr_b16 v[56:57], v14 offset:55296
    ds_read_b64_tr_b16 v[58:59], v14 offset:56320
    v_mfma_f32_32x32x16_bf16 v[32:47], v[52:55], v[184:187], v[32:47]
    ds_read_b64_tr_b16 v[60:61], v15 offset:55296
    ds_read_b64_tr_b16 v[62:63], v15 offset:56320
    s_add_u32 s22, s45, 8192
    buffer_load_dwordx4 v[144:147], v131, s[8:11], s22 offen offset:0 sc1
    s_waitcnt lgkmcnt(0)
    s_barrier
    s_waitcnt vmcnt(13)
    v_mfma_f32_32x32x16_bf16 v[16:31], v[56:59], v[188:191], v[16:31]
    ds_read_b64_tr_b16 v[48:49], v128 offset:0
    ds_read_b64_tr_b16 v[50:51], v128 offset:1024
    v_mfma_f32_32x32x16_bf16 v[32:47], v[60:63], v[188:191], v[32:47]
    ds_read_b64_tr_b16 v[52:53], v129 offset:0
    ds_read_b64_tr_b16 v[54:55], v129 offset:1024
    s_sub_u32 m0, s28, 22528
    s_mov_b32 s29, 917504
    buffer_load_dwordx4 v216, s[12:15], s29 offen lds
    s_sub_u32 m0, s28, 21504
    s_nop 0
    buffer_load_dwordx4 v217, s[12:15], s29 offen lds
    buffer_load_dwordx4 v[148:151], v131, s[8:11], s22 offen offset:1024 sc1
    s_waitcnt lgkmcnt(0)
    s_waitcnt vmcnt(13)
    v_mfma_f32_32x32x16_bf16 v[16:31], v[48:51], v[192:195], v[16:31]
    ds_read_b64_tr_b16 v[56:57], v128 offset:2048
    ds_read_b64_tr_b16 v[58:59], v128 offset:3072
    v_mfma_f32_32x32x16_bf16 v[32:47], v[52:55], v[192:195], v[32:47]
    ds_read_b64_tr_b16 v[60:61], v129 offset:2048
    ds_read_b64_tr_b16 v[62:63], v129 offset:3072
    buffer_load_dwordx4 v[152:155], v131, s[8:11], s22 offen offset:2048 sc1
    s_waitcnt lgkmcnt(0)
    s_waitcnt vmcnt(13)
    v_mfma_f32_32x32x16_bf16 v[16:31], v[56:59], v[196:199], v[16:31]
    ds_read_b64_tr_b16 v[48:49], v128 offset:4096
    ds_read_b64_tr_b16 v[50:51], v128 offset:5120
    v_mfma_f32_32x32x16_bf16 v[32:47], v[60:63], v[196:199], v[32:47]
    ds_read_b64_tr_b16 v[52:53], v129 offset:4096
    ds_read_b64_tr_b16 v[54:55], v129 offset:5120
    buffer_load_dwordx4 v[156:159], v131, s[8:11], s22 offen offset:3072 sc1
    s_waitcnt lgkmcnt(0)
    s_waitcnt vmcnt(13)
    v_mfma_f32_32x32x16_bf16 v[16:31], v[48:51], v[200:203], v[16:31]
    ds_read_b64_tr_b16 v[56:57], v128 offset:6144
    ds_read_b64_tr_b16 v[58:59], v128 offset:7168
    v_mfma_f32_32x32x16_bf16 v[32:47], v[52:55], v[200:203], v[32:47]
    ds_read_b64_tr_b16 v[60:61], v129 offset:6144
    ds_read_b64_tr_b16 v[62:63], v129 offset:7168
    s_add_u32 s22, s45, 12288
    buffer_load_dwordx4 v[160:163], v131, s[8:11], s22 offen offset:0 sc1
    s_waitcnt lgkmcnt(0)
    s_barrier
    s_waitcnt vmcnt(13)
    v_mfma_f32_32x32x16_bf16 v[16:31], v[56:59], v[204:207], v[16:31]
    ds_read_b64_tr_b16 v[48:49], v128 offset:16384
    ds_read_b64_tr_b16 v[50:51], v128 offset:17408
    v_mfma_f32_32x32x16_bf16 v[32:47], v[60:63], v[204:207], v[32:47]
    ds_read_b64_tr_b16 v[52:53], v129 offset:16384
    ds_read_b64_tr_b16 v[54:55], v129 offset:17408
    buffer_load_dwordx4 v[164:167], v131, s[8:11], s22 offen offset:1024 sc1
    s_waitcnt lgkmcnt(0)
    s_waitcnt vmcnt(11)
    v_mfma_f32_32x32x16_bf16 v[16:31], v[48:51], v[224:227], v[16:31]
    ds_read_b64_tr_b16 v[56:57], v128 offset:18432
    ds_read_b64_tr_b16 v[58:59], v128 offset:19456
    v_mfma_f32_32x32x16_bf16 v[32:47], v[52:55], v[224:227], v[32:47]
    ds_read_b64_tr_b16 v[60:61], v129 offset:18432
    ds_read_b64_tr_b16 v[62:63], v129 offset:19456
    buffer_load_dwordx4 v[168:171], v131, s[8:11], s22 offen offset:2048 sc1
    s_waitcnt lgkmcnt(0)
    s_waitcnt vmcnt(11)
    v_mfma_f32_32x32x16_bf16 v[16:31], v[56:59], v[228:231], v[16:31]
    ds_read_b64_tr_b16 v[48:49], v128 offset:20480
    ds_read_b64_tr_b16 v[50:51], v128 offset:21504
    v_mfma_f32_32x32x16_bf16 v[32:47], v[60:63], v[228:231], v[32:47]
    ds_read_b64_tr_b16 v[52:53], v129 offset:20480
    ds_read_b64_tr_b16 v[54:55], v129 offset:21504
    buffer_load_dwordx4 v[172:175], v131, s[8:11], s22 offen offset:3072 sc1
    s_add_u32 s22, s45, 16384
    buffer_load_dwordx4 v[176:179], v131, s[8:11], s22 offen offset:0 sc1
    s_waitcnt lgkmcnt(0)
    s_waitcnt vmcnt(12)
    v_mfma_f32_32x32x16_bf16 v[16:31], v[48:51], v[232:235], v[16:31]
    ds_read_b64_tr_b16 v[56:57], v128 offset:22528
    ds_read_b64_tr_b16 v[58:59], v128 offset:23552
    v_mfma_f32_32x32x16_bf16 v[32:47], v[52:55], v[232:235], v[32:47]
    ds_read_b64_tr_b16 v[60:61], v129 offset:22528
    ds_read_b64_tr_b16 v[62:63], v129 offset:23552
    buffer_load_dwordx4 v[180:183], v131, s[8:11], s22 offen offset:1024 sc1
    s_waitcnt lgkmcnt(0)
    s_barrier
    s_waitcnt vmcnt(12)
    v_mfma_f32_32x32x16_bf16 v[16:31], v[56:59], v[236:239], v[16:31]
    ds_read_b64_tr_b16 v[48:49], v128 offset:32768
    ds_read_b64_tr_b16 v[50:51], v128 offset:33792
    v_mfma_f32_32x32x16_bf16 v[32:47], v[60:63], v[236:239], v[32:47]
    ds_read_b64_tr_b16 v[52:53], v129 offset:32768
    ds_read_b64_tr_b16 v[54:55], v129 offset:33792
    buffer_load_dwordx4 v[184:187], v131, s[8:11], s22 offen offset:2048 sc1
    s_waitcnt lgkmcnt(0)
    s_waitcnt vmcnt(12)
    v_mfma_f32_32x32x16_bf16 v[16:31], v[48:51], v[144:147], v[16:31]
    ds_read_b64_tr_b16 v[56:57], v128 offset:34816
    ds_read_b64_tr_b16 v[58:59], v128 offset:35840
    v_mfma_f32_32x32x16_bf16 v[32:47], v[52:55], v[144:147], v[32:47]
    ds_read_b64_tr_b16 v[60:61], v129 offset:34816
    ds_read_b64_tr_b16 v[62:63], v129 offset:35840
    buffer_load_dwordx4 v[188:191], v131, s[8:11], s22 offen offset:3072 sc1
    s_waitcnt lgkmcnt(0)
    s_waitcnt vmcnt(10)
    v_mfma_f32_32x32x16_bf16 v[16:31], v[56:59], v[148:151], v[16:31]
    ds_read_b64_tr_b16 v[48:49], v128 offset:36864
    ds_read_b64_tr_b16 v[50:51], v128 offset:37888
    v_mfma_f32_32x32x16_bf16 v[32:47], v[60:63], v[148:151], v[32:47]
    ds_read_b64_tr_b16 v[52:53], v129 offset:36864
    ds_read_b64_tr_b16 v[54:55], v129 offset:37888
    s_add_u32 s22, s45, 20480
    buffer_load_dwordx4 v[192:195], v131, s[8:11], s22 offen offset:0 sc1
    s_waitcnt lgkmcnt(0)
    s_waitcnt vmcnt(10)
    v_mfma_f32_32x32x16_bf16 v[16:31], v[48:51], v[152:155], v[16:31]
    ds_read_b64_tr_b16 v[56:57], v128 offset:38912
    ds_read_b64_tr_b16 v[58:59], v128 offset:39936
    v_mfma_f32_32x32x16_bf16 v[32:47], v[52:55], v[152:155], v[32:47]
    ds_read_b64_tr_b16 v[60:61], v129 offset:38912
    ds_read_b64_tr_b16 v[62:63], v129 offset:39936
    buffer_load_dwordx4 v[196:199], v131, s[8:11], s22 offen offset:1024 sc1
    s_waitcnt lgkmcnt(0)
    s_barrier
    s_waitcnt vmcnt(10)
    v_mfma_f32_32x32x16_bf16 v[16:31], v[56:59], v[156:159], v[16:31]
    ds_read_b64_tr_b16 v[48:49], v128 offset:49152
    ds_read_b64_tr_b16 v[50:51], v128 offset:50176
    v_mfma_f32_32x32x16_bf16 v[32:47], v[60:63], v[156:159], v[32:47]
    ds_read_b64_tr_b16 v[52:53], v129 offset:49152
    ds_read_b64_tr_b16 v[54:55], v129 offset:50176
    buffer_load_dwordx4 v[200:203], v131, s[8:11], s22 offen offset:2048 sc1
    s_waitcnt lgkmcnt(0)
    s_waitcnt vmcnt(10)
    v_mfma_f32_32x32x16_bf16 v[16:31], v[48:51], v[160:163], v[16:31]
    ds_read_b64_tr_b16 v[56:57], v128 offset:51200
    ds_read_b64_tr_b16 v[58:59], v128 offset:52224
    v_mfma_f32_32x32x16_bf16 v[32:47], v[52:55], v[160:163], v[32:47]
    ds_read_b64_tr_b16 v[60:61], v129 offset:51200
    ds_read_b64_tr_b16 v[62:63], v129 offset:52224
    buffer_load_dwordx4 v[204:207], v131, s[8:11], s22 offen offset:3072 sc1
    s_waitcnt lgkmcnt(0)
    s_waitcnt vmcnt(10)
    v_mfma_f32_32x32x16_bf16 v[16:31], v[56:59], v[164:167], v[16:31]
    ds_read_b64_tr_b16 v[48:49], v128 offset:53248
    ds_read_b64_tr_b16 v[50:51], v128 offset:54272
    v_mfma_f32_32x32x16_bf16 v[32:47], v[60:63], v[164:167], v[32:47]
    ds_read_b64_tr_b16 v[52:53], v129 offset:53248
    ds_read_b64_tr_b16 v[54:55], v129 offset:54272
    s_add_u32 s22, s45, 24576
    buffer_load_dwordx4 v[224:227], v131, s[8:11], s22 offen offset:0 sc1
    s_waitcnt lgkmcnt(0)
    s_waitcnt vmcnt(10)
    v_mfma_f32_32x32x16_bf16 v[16:31], v[48:51], v[168:171], v[16:31]
    ds_read_b64_tr_b16 v[56:57], v128 offset:55296
    ds_read_b64_tr_b16 v[58:59], v128 offset:56320
    v_mfma_f32_32x32x16_bf16 v[32:47], v[52:55], v[168:171], v[32:47]
    ds_read_b64_tr_b16 v[60:61], v129 offset:55296
    ds_read_b64_tr_b16 v[62:63], v129 offset:56320
    buffer_load_dwordx4 v[228:231], v131, s[8:11], s22 offen offset:1024 sc1
    buffer_load_dwordx4 v[232:235], v131, s[8:11], s22 offen offset:2048 sc1
    s_waitcnt lgkmcnt(0)
    s_barrier
    s_waitcnt vmcnt(11)
    v_mfma_f32_32x32x16_bf16 v[16:31], v[56:59], v[172:175], v[16:31]
    ds_read_b64_tr_b16 v[48:49], v14 offset:0
    ds_read_b64_tr_b16 v[50:51], v14 offset:1024
    v_mfma_f32_32x32x16_bf16 v[32:47], v[60:63], v[172:175], v[32:47]
    ds_read_b64_tr_b16 v[52:53], v15 offset:0
    ds_read_b64_tr_b16 v[54:55], v15 offset:1024
    buffer_load_dwordx4 v[236:239], v131, s[8:11], s22 offen offset:3072 sc1
    s_waitcnt lgkmcnt(0)
    s_waitcnt vmcnt(11)
    v_mfma_f32_32x32x16_bf16 v[16:31], v[48:51], v[176:179], v[16:31]
    ds_read_b64_tr_b16 v[56:57], v14 offset:2048
    ds_read_b64_tr_b16 v[58:59], v14 offset:3072
    v_mfma_f32_32x32x16_bf16 v[32:47], v[52:55], v[176:179], v[32:47]
    ds_read_b64_tr_b16 v[60:61], v15 offset:2048
    ds_read_b64_tr_b16 v[62:63], v15 offset:3072
    s_add_u32 s22, s45, 28672
    buffer_load_dwordx4 v[144:147], v131, s[8:11], s22 offen offset:0 sc1
    s_waitcnt lgkmcnt(0)
    s_waitcnt vmcnt(11)
    v_mfma_f32_32x32x16_bf16 v[16:31], v[56:59], v[180:183], v[16:31]
    ds_read_b64_tr_b16 v[48:49], v14 offset:4096
    ds_read_b64_tr_b16 v[50:51], v14 offset:5120
    v_mfma_f32_32x32x16_bf16 v[32:47], v[60:63], v[180:183], v[32:47]
    ds_read_b64_tr_b16 v[52:53], v15 offset:4096
    ds_read_b64_tr_b16 v[54:55], v15 offset:5120
    buffer_load_dwordx4 v[148:151], v131, s[8:11], s22 offen offset:1024 sc1
    s_waitcnt lgkmcnt(0)
    s_waitcnt vmcnt(11)
    v_mfma_f32_32x32x16_bf16 v[16:31], v[48:51], v[184:187], v[16:31]
    ds_read_b64_tr_b16 v[56:57], v14 offset:6144
    ds_read_b64_tr_b16 v[58:59], v14 offset:7168
    v_mfma_f32_32x32x16_bf16 v[32:47], v[52:55], v[184:187], v[32:47]
    ds_read_b64_tr_b16 v[60:61], v15 offset:6144
    ds_read_b64_tr_b16 v[62:63], v15 offset:7168
    buffer_load_dwordx4 v[152:155], v131, s[8:11], s22 offen offset:2048 sc1
    s_waitcnt lgkmcnt(0)
    s_barrier
    s_waitcnt vmcnt(11)
    v_mfma_f32_32x32x16_bf16 v[16:31], v[56:59], v[188:191], v[16:31]
    ds_read_b64_tr_b16 v[48:49], v14 offset:16384
    ds_read_b64_tr_b16 v[50:51], v14 offset:17408
    v_mfma_f32_32x32x16_bf16 v[32:47], v[60:63], v[188:191], v[32:47]
    ds_read_b64_tr_b16 v[52:53], v15 offset:16384
    ds_read_b64_tr_b16 v[54:55], v15 offset:17408
    buffer_load_dwordx4 v[156:159], v131, s[8:11], s22 offen offset:3072 sc1
    s_waitcnt lgkmcnt(0)
    s_waitcnt vmcnt(11)
    v_mfma_f32_32x32x16_bf16 v[16:31], v[48:51], v[192:195], v[16:31]
    ds_read_b64_tr_b16 v[56:57], v14 offset:18432
    ds_read_b64_tr_b16 v[58:59], v14 offset:19456
    v_mfma_f32_32x32x16_bf16 v[32:47], v[52:55], v[192:195], v[32:47]
    ds_read_b64_tr_b16 v[60:61], v15 offset:18432
    ds_read_b64_tr_b16 v[62:63], v15 offset:19456
    s_waitcnt lgkmcnt(0)
    s_waitcnt vmcnt(10)
    v_mfma_f32_32x32x16_bf16 v[16:31], v[56:59], v[196:199], v[16:31]
    ds_read_b64_tr_b16 v[48:49], v14 offset:20480
    ds_read_b64_tr_b16 v[50:51], v14 offset:21504
    v_mfma_f32_32x32x16_bf16 v[32:47], v[60:63], v[196:199], v[32:47]
    ds_read_b64_tr_b16 v[52:53], v15 offset:20480
    ds_read_b64_tr_b16 v[54:55], v15 offset:21504
    s_waitcnt lgkmcnt(0)
    s_waitcnt vmcnt(9)
    v_mfma_f32_32x32x16_bf16 v[16:31], v[48:51], v[200:203], v[16:31]
    ds_read_b64_tr_b16 v[56:57], v14 offset:22528
    ds_read_b64_tr_b16 v[58:59], v14 offset:23552
    v_mfma_f32_32x32x16_bf16 v[32:47], v[52:55], v[200:203], v[32:47]
    ds_read_b64_tr_b16 v[60:61], v15 offset:22528
    ds_read_b64_tr_b16 v[62:63], v15 offset:23552
    s_waitcnt lgkmcnt(0)
    s_barrier
    s_waitcnt vmcnt(8)
    v_mfma_f32_32x32x16_bf16 v[16:31], v[56:59], v[204:207], v[16:31]
    ds_read_b64_tr_b16 v[48:49], v14 offset:32768
    ds_read_b64_tr_b16 v[50:51], v14 offset:33792
    v_mfma_f32_32x32x16_bf16 v[32:47], v[60:63], v[204:207], v[32:47]
    ds_read_b64_tr_b16 v[52:53], v15 offset:32768
    ds_read_b64_tr_b16 v[54:55], v15 offset:33792
    s_waitcnt lgkmcnt(0)
    s_waitcnt vmcnt(7)
    v_mfma_f32_32x32x16_bf16 v[16:31], v[48:51], v[224:227], v[16:31]
    ds_read_b64_tr_b16 v[56:57], v14 offset:34816
    ds_read_b64_tr_b16 v[58:59], v14 offset:35840
    v_mfma_f32_32x32x16_bf16 v[32:47], v[52:55], v[224:227], v[32:47]
    ds_read_b64_tr_b16 v[60:61], v15 offset:34816
    ds_read_b64_tr_b16 v[62:63], v15 offset:35840
    s_waitcnt lgkmcnt(0)
    s_waitcnt vmcnt(6)
    v_mfma_f32_32x32x16_bf16 v[16:31], v[56:59], v[228:231], v[16:31]
    ds_read_b64_tr_b16 v[48:49], v14 offset:36864
    ds_read_b64_tr_b16 v[50:51], v14 offset:37888
    v_mfma_f32_32x32x16_bf16 v[32:47], v[60:63], v[228:231], v[32:47]
    ds_read_b64_tr_b16 v[52:53], v15 offset:36864
    ds_read_b64_tr_b16 v[54:55], v15 offset:37888
    s_waitcnt lgkmcnt(0)
    s_waitcnt vmcnt(5)
    v_mfma_f32_32x32x16_bf16 v[16:31], v[48:51], v[232:235], v[16:31]
    ds_read_b64_tr_b16 v[56:57], v14 offset:38912
    ds_read_b64_tr_b16 v[58:59], v14 offset:39936
    v_mfma_f32_32x32x16_bf16 v[32:47], v[52:55], v[232:235], v[32:47]
    ds_read_b64_tr_b16 v[60:61], v15 offset:38912
    ds_read_b64_tr_b16 v[62:63], v15 offset:39936
    s_waitcnt lgkmcnt(0)
    s_barrier
    s_waitcnt vmcnt(4)
    v_mfma_f32_32x32x16_bf16 v[16:31], v[56:59], v[236:239], v[16:31]
    ds_read_b64_tr_b16 v[48:49], v14 offset:49152
    ds_read_b64_tr_b16 v[50:51], v14 offset:50176
    v_mfma_f32_32x32x16_bf16 v[32:47], v[60:63], v[236:239], v[32:47]
    ds_read_b64_tr_b16 v[52:53], v15 offset:49152
    ds_read_b64_tr_b16 v[54:55], v15 offset:50176
    s_waitcnt lgkmcnt(0)
    s_waitcnt vmcnt(3)
    v_mfma_f32_32x32x16_bf16 v[16:31], v[48:51], v[144:147], v[16:31]
    ds_read_b64_tr_b16 v[56:57], v14 offset:51200
    ds_read_b64_tr_b16 v[58:59], v14 offset:52224
    v_mfma_f32_32x32x16_bf16 v[32:47], v[52:55], v[144:147], v[32:47]
    ds_read_b64_tr_b16 v[60:61], v15 offset:51200
    ds_read_b64_tr_b16 v[62:63], v15 offset:52224
    s_waitcnt lgkmcnt(0)
    s_waitcnt vmcnt(2)
    v_mfma_f32_32x32x16_bf16 v[16:31], v[56:59], v[148:151], v[16:31]
    ds_read_b64_tr_b16 v[48:49], v14 offset:53248
    ds_read_b64_tr_b16 v[50:51], v14 offset:54272
    v_mfma_f32_32x32x16_bf16 v[32:47], v[60:63], v[148:151], v[32:47]
    ds_read_b64_tr_b16 v[52:53], v15 offset:53248
    ds_read_b64_tr_b16 v[54:55], v15 offset:54272
    s_waitcnt lgkmcnt(0)
    s_waitcnt vmcnt(1)
    v_mfma_f32_32x32x16_bf16 v[16:31], v[48:51], v[152:155], v[16:31]
    ds_read_b64_tr_b16 v[56:57], v14 offset:55296
    ds_read_b64_tr_b16 v[58:59], v14 offset:56320
    v_mfma_f32_32x32x16_bf16 v[32:47], v[52:55], v[152:155], v[32:47]
    ds_read_b64_tr_b16 v[60:61], v15 offset:55296
    ds_read_b64_tr_b16 v[62:63], v15 offset:56320
    s_waitcnt lgkmcnt(0)
    s_waitcnt vmcnt(0)
    v_mfma_f32_32x32x16_bf16 v[32:47], v[60:63], v[156:159], v[32:47]
    v_mfma_f32_32x32x16_bf16 v[16:31], v[56:59], v[156:159], v[16:31]
    s_nop 10
    ds_write_b128 v133, v[32:35] offset:0
    ds_write_b128 v133, v[36:39] offset:1024
    ds_write_b128 v133, v[40:43] offset:2048
    ds_write_b128 v133, v[44:47] offset:3072
    s_waitcnt lgkmcnt(0)
    s_barrier
    ds_read_b128 v[144:147], v134 offset:0
    ds_read_b128 v[148:151], v134 offset:1024
    ds_read_b128 v[152:155], v134 offset:2048
    ds_read_b128 v[156:159], v134 offset:3072
    s_waitcnt lgkmcnt(3)
    v_pk_add_f32 v[16:17], v[16:17], v[144:145]
    v_pk_add_f32 v[18:19], v[18:19], v[146:147]
    v_cvt_pk_bf16_f32 v32, v16, v17
    v_cvt_pk_bf16_f32 v33, v18, v19
    ds_write_b64 v136, v[32:33]
    s_waitcnt lgkmcnt(3)
    v_pk_add_f32 v[20:21], v[20:21], v[148:149]
    v_pk_add_f32 v[22:23], v[22:23], v[150:151]
    v_cvt_pk_bf16_f32 v34, v20, v21
    v_cvt_pk_bf16_f32 v35, v22, v23
    ds_write_b64 v137, v[34:35]
    s_waitcnt lgkmcnt(3)
    v_pk_add_f32 v[24:25], v[24:25], v[152:153]
    v_pk_add_f32 v[26:27], v[26:27], v[154:155]
    v_cvt_pk_bf16_f32 v36, v24, v25
    v_cvt_pk_bf16_f32 v37, v26, v27
    ds_write_b64 v138, v[36:37]
    s_waitcnt lgkmcnt(3)
    v_pk_add_f32 v[28:29], v[28:29], v[156:157]
    v_pk_add_f32 v[30:31], v[30:31], v[158:159]
    v_cvt_pk_bf16_f32 v38, v28, v29
    v_cvt_pk_bf16_f32 v39, v30, v31
    ds_write_b64 v139, v[38:39]
    ds_read_b128 v[144:147], v140 offset:0
    ds_read_b128 v[148:151], v140 offset:1024
    s_waitcnt lgkmcnt(1)
    buffer_store_dwordx4 v[144:147], v135, s[16:19], s43 offen sc1
    s_waitcnt lgkmcnt(0)
    buffer_store_dwordx4 v[148:151], v135, s[16:19], s44 offen sc1
K3_END2:
K2_END:
    s_endpgm
K2_SLOW:
    s_lshl_b32 s36, s33, 18
    s_add_u32 s36, s36, 4194304
    s_mov_b32 s38, 64
    v_mov_b32 v5, 0xff61b1e6
    v_mov_b32 v88, 0
    v_mov_b32 v89, 0
    v_mov_b32 v90, 0
    v_mov_b32 v91, 0
    v_mov_b32 v92, 0
    v_mov_b32 v93, 0
    v_mov_b32 v94, 0
    v_mov_b32 v95, 0
    v_mov_b32 v96, 0
    v_mov_b32 v97, 0
    v_mov_b32 v98, 0
    v_mov_b32 v99, 0
    v_mov_b32 v100, 0
    v_mov_b32 v101, 0
    v_mov_b32 v102, 0
    v_mov_b32 v103, 0
    v_mov_b32 v104, 0
    v_mov_b32 v105, 0
    v_mov_b32 v106, 0
    v_mov_b32 v107, 0
K2_SLOW_LOOP:
    buffer_load_dwordx4 v[24:27], v131, s[8:11], s36 offen offset:0 sc1
    buffer_load_dwordx4 v[28:31], v131, s[8:11], s36 offen offset:1024 sc1
    buffer_load_dwordx4 v[32:35], v131, s[8:11], s36 offen offset:2048 sc1
    buffer_load_dwordx4 v[36:39], v131, s[8:11], s36 offen offset:3072 sc1
    s_add_u32 s36, s36, 4096
    s_waitcnt vmcnt(0)
    v_mfma_f32_32x32x16_bf16 v[40:55], v[24:27], v[16:19], 0
    v_mfma_f32_32x32x16_bf16 v[40:55], v[28:31], v[20:23], v[40:55]
    s_nop 11
    v_max3_f32 v6, v40, v41, v42
    v_max3_f32 v6, v6, v43, v44
    v_max3_f32 v6, v6, v45, v46
    v_max3_f32 v6, v6, v47, v48
    v_max3_f32 v6, v6, v49, v50
    v_max3_f32 v6, v6, v51, v52
    v_max3_f32 v6, v6, v53, v54
    v_max_f32 v6, v6, v55
    v_mov_b32 v3, v6
    s_nop 1
    v_permlane32_swap_b32 v6, v3
    v_max_f32 v6, v6, v3
    v_max_f32 v6, v6, v5
    v_sub_f32 v7, v5, v6
    v_exp_f32 v7, v7
    v_mov_b32 v5, v6
    v_sub_f32 v40, v40, v6
    v_sub_f32 v41, v41, v6
    v_sub_f32 v42, v42, v6
    v_sub_f32 v43, v43, v6
    v_sub_f32 v44, v44, v6
    v_sub_f32 v45, v45, v6
    v_sub_f32 v46, v46, v6
    v_sub_f32 v47, v47, v6
    v_sub_f32 v48, v48, v6
    v_sub_f32 v49, v49, v6
    v_sub_f32 v50, v50, v6
    v_sub_f32 v51, v51, v6
    v_sub_f32 v52, v52, v6
    v_sub_f32 v53, v53, v6
    v_sub_f32 v54, v54, v6
    v_sub_f32 v55, v55, v6
    v_exp_f32 v40, v40
    v_exp_f32 v41, v41
    v_exp_f32 v42, v42
    v_exp_f32 v43, v43
    v_exp_f32 v44, v44
    v_exp_f32 v45, v45
    v_exp_f32 v46, v46
    v_exp_f32 v47, v47
    v_exp_f32 v48, v48
    v_exp_f32 v49, v49
    v_exp_f32 v50, v50
    v_exp_f32 v51, v51
    v_exp_f32 v52, v52
    v_exp_f32 v53, v53
    v_exp_f32 v54, v54
    v_exp_f32 v55, v55
    v_mul_f32 v88, v88, v7
    v_mul_f32 v89, v89, v7
    v_mul_f32 v90, v90, v7
    v_mul_f32 v91, v91, v7
    v_mul_f32 v92, v92, v7
    v_mul_f32 v93, v93, v7
    v_mul_f32 v94, v94, v7
    v_mul_f32 v95, v95, v7
    v_mul_f32 v96, v96, v7
    v_mul_f32 v97, v97, v7
    v_mul_f32 v98, v98, v7
    v_mul_f32 v99, v99, v7
    v_mul_f32 v100, v100, v7
    v_mul_f32 v101, v101, v7
    v_mul_f32 v102, v102, v7
    v_mul_f32 v103, v103, v7
    v_mul_f32 v104, v104, v7
    v_mul_f32 v105, v105, v7
    v_cvt_pk_bf16_f32 v72, v40, v41
    v_cvt_pk_bf16_f32 v73, v42, v43
    v_cvt_pk_bf16_f32 v74, v44, v45
    v_cvt_pk_bf16_f32 v75, v46, v47
    v_cvt_pk_bf16_f32 v76, v48, v49
    v_cvt_pk_bf16_f32 v77, v50, v51
    v_cvt_pk_bf16_f32 v78, v52, v53
    v_cvt_pk_bf16_f32 v79, v54, v55
    v_mfma_f32_32x32x16_bf16 v[88:103], v[32:35], v[72:75], v[88:103]
    s_nop 0
    v_mfma_f32_32x32x16_bf16 v[88:103], v[36:39], v[76:79], v[88:103]
    v_smfmac_f32_16x16x64_bf16 v[104:107], v[124:127], v[72:79], v215
    s_sub_u32 s38, s38, 1
    s_cmp_lg_u32 s38, 0
    s_cbranch_scc1 K2_SLOW_LOOP
    s_nop 15
    v_add_f32 v104, v104, v105
    s_branch K2_FIN
M_LSPINalpha:
    s_mov_b32 s101, 0
M_LSPINalpha_L:
    s_mov_b32 s96, s94
    s_mov_b32 s97, s95
    s_mov_b32 s98, 0x100
    s_mov_b32 s99, 0x20000
    buffer_load_dword v252, v253, s[96:99], 0 offen sc1
    s_add_u32 s101, s101, 1
    s_cmp_ge_u32 s101, 1048576
    s_cbranch_scc1 M_LSPINalpha_X
    s_waitcnt vmcnt(0)
    v_cmp_ne_u32 vcc, 1, v252
    s_cbranch_vccnz M_LSPINalpha_L
M_LSPINalpha_X:
    s_waitcnt vmcnt(0)
    s_branch M_LOKalpha
M_LSPINbeta:
    s_mov_b32 s101, 0
M_LSPINbeta_L:
    s_mov_b32 s96, s94
    s_mov_b32 s97, s95
    s_mov_b32 s98, 0x100
    s_mov_b32 s99, 0x20000
    buffer_load_dword v252, v253, s[96:99], 0 offen sc1
    s_add_u32 s101, s101, 1
    s_cmp_ge_u32 s101, 1048576
    s_cbranch_scc1 M_LSPINbeta_X
    s_waitcnt vmcnt(0)
    v_cmp_ne_u32 vcc, 1, v252
    s_cbranch_vccnz M_LSPINbeta_L
M_LSPINbeta_X:
    s_waitcnt vmcnt(0)
    s_branch M_LOKbeta
M_ESPIN:
    s_mov_b32 s101, 0
M_ESPIN_L:
    buffer_load_dword v252, v12, s[8:11], s100 offen sc1
    s_add_u32 s101, s101, 1
    s_cmp_ge_u32 s101, 1048576
    s_cbranch_scc1 M_ESPIN_X
    s_waitcnt vmcnt(0)
    v_cmp_ne_u32 vcc, 1, v252
    s_cbranch_vccnz M_ESPIN_L
M_ESPIN_X:
    s_waitcnt vmcnt(0)
    s_branch M_EOK
M_FSPIN:
    s_mov_b32 s101, 0
M_FSPIN_L:
    buffer_load_dword v229, v253, s[8:11], s100 offen sc1
    s_add_u32 s101, s101, 1
    s_cmp_ge_u32 s101, 1048576
    s_cbranch_scc1 M_FSPIN_X
    s_waitcnt vmcnt(0)
    v_cmp_ne_u32 vcc, 1, v229
    s_cbranch_vccnz M_FSPIN_L
M_FSPIN_X:
    s_waitcnt vmcnt(0)
    s_branch M_FOK
M_ASPIN:
    s_mov_b32 s101, 0
M_ASPIN_L:
    buffer_load_dword v220, v222, s[8:11], s60 offen offset:128 sc1
    s_add_u32 s101, s101, 1
    s_cmp_ge_u32 s101, 1048576
    s_cbranch_scc1 M_ASPIN_X
    s_waitcnt vmcnt(0)
    v_cmp_ne_u32 vcc, 1, v220
    s_cbranch_vccnz M_ASPIN_L
M_ASPIN_X:
    s_waitcnt vmcnt(0)
    s_branch M_AOK
M_BSPIN:
    s_mov_b32 s101, 0
M_BSPIN_L:
    buffer_load_dword v220, v222, s[8:11], s60 offen offset:0 sc1
    s_add_u32 s101, s101, 1
    s_cmp_ge_u32 s101, 1048576
    s_cbranch_scc1 M_BSPIN_X
    s_waitcnt vmcnt(0)
    v_cmp_ne_u32 vcc, 1, v220
    s_cbranch_vccnz M_BSPIN_L
M_BSPIN_X:
    s_waitcnt vmcnt(0)
    s_branch M_BOK
M_GSPIN:
    s_mov_b32 s101, 0
M_GSPIN_L:
    buffer_load_dword v228, v226, s[8:11], s100 offen sc1
    s_add_u32 s101, s101, 1
    s_cmp_ge_u32 s101, 1048576
    s_cbranch_scc1 M_GSPIN_X
    s_waitcnt vmcnt(0)
    v_cmp_ne_u32 vcc, 1, v228
    s_cbranch_vccnz M_GSPIN_L
M_GSPIN_X:
    s_waitcnt vmcnt(0)
    s_branch M_GOK
K1_END:
    s_endpgm
.section .rodata,"a"
.p2align 6
.amdhsa_kernel qkv_kernel
  .amdhsa_next_free_vgpr 256
  .amdhsa_next_free_sgpr 102
  .amdhsa_accum_offset 256
  .amdhsa_group_segment_fixed_size 0
  .amdhsa_kernarg_size 88
  .amdhsa_user_sgpr_count 2
  .amdhsa_user_sgpr_kernarg_segment_ptr 1
  .amdhsa_system_sgpr_workgroup_id_x 1
.end_amdhsa_kernel
```
